```python
import torch

def _softmax(x, axis=-1):
    return torch.softmax(x, dim=axis)
def _gelu(x):
    return torch.nn.functional.gelu(x, approximate="tanh")
def _silu(x):
    return torch.nn.functional.silu(x)
def _sigmoid(x):
    return torch.sigmoid(x)
def _layernorm(x, axis=-1, eps=1e-5):
    m = x.mean(dim=axis, keepdim=True)
    v = x.var(dim=axis, keepdim=True, unbiased=False)
    return (x - m) / torch.sqrt(v + eps)
def _scatter_add(tgt, idx, src, axis=0):
    return tgt.clone().index_add_(axis, idx, src)
def _segment_sum(src, seg, n):
    out = torch.zeros((n,) + src.shape[1:], dtype=src.dtype)
    return out.index_add_(0, seg, src)
def _pad(x, pw):
    flat = tuple(v for pair in reversed(pw) for v in pair)
    return torch.nn.functional.pad(x, flat)

kernel_name = 'recurrent_scan__grouped_kv_mqa__mixer_s_mlp__prompt'

def setup_inputs():

    _w = (lambda a: (lambda t: t.to(torch.bfloat16) if t.is_floating_point() else t)(torch.as_tensor(a)))
    def _A_setup():
        B, S, D, H = 1, 2048, 448, 16
        Dh = D // H
        return {
            "x": _w((lambda *s: torch.randn(*s, dtype=torch.bfloat16) * 0.05)(B, S, D)),
            "wq": _w((lambda *s: torch.randn(*s, dtype=torch.bfloat16) * 0.05)(D, H * Dh)),
            "wk": _w((lambda *s: torch.randn(*s, dtype=torch.bfloat16) * 0.05)(D, Dh)),
            "wv": _w((lambda *s: torch.randn(*s, dtype=torch.bfloat16) * 0.05)(D, Dh)),
            "wo": _w((lambda *s: torch.randn(*s, dtype=torch.bfloat16) * 0.05)(H * Dh, D)),
        }
    _A_in = _A_setup()

    def _B_setup():
        B, S, D, F = 1, 2048, 448, 1792
        return {
            "x":  _w((lambda *s: torch.randn(*s, dtype=torch.bfloat16) * 0.05)(B, S, D)),
            "w1": _w((lambda *s: torch.randn(*s, dtype=torch.bfloat16) * 3.2)(D, D) * (D ** -0.5)),
            "w2": _w((lambda *s: torch.randn(*s, dtype=torch.bfloat16) * 3.2)(D, D) * (D ** -0.5)),
            "w3": _w((lambda *s: torch.randn(*s, dtype=torch.bfloat16) * 3.2)(D, F) * (D ** -0.5)),
            "w4": _w((lambda *s: torch.randn(*s, dtype=torch.bfloat16) * 3.2)(F, D) * (F ** -0.5)),
        }
    _B_in = _B_setup()

    return {
        "A_x": _A_in["x"],
        "A_wq": _A_in["wq"],
        "A_wk": _A_in["wk"],
        "A_wv": _A_in["wv"],
        "A_wo": _A_in["wo"],
        "B_x": _B_in["x"],
        "B_w1": _B_in["w1"],
        "B_w2": _B_in["w2"],
        "B_w3": _B_in["w3"],
        "B_w4": _B_in["w4"],
    }

def reference(A_x, A_wq, A_wk, A_wv, A_wo, B_x, B_w1, B_w2, B_w3, B_w4):
    def _A_ref(x, wq, wk, wv, wo):
        B, S, D = x.shape
        H = 16
        Dh = D // H
        q = (lambda x, *d: x.permute(*d))((x @ wq).reshape(B, S, H, Dh), 0, 2, 1, 3)
        k = x @ wk
        v = x @ wv
        scores = torch.einsum("bhqd,bkd->bhqk", q, k) * (Dh ** -0.5)
        p = _softmax(scores, axis=-1)
        o = torch.einsum("bhqk,bkd->bhqd", p, v)
        return (lambda x, *d: x.permute(*d))(o, 0, 2, 1, 3).reshape(B, S, H * Dh) @ wo

    def _B_ref(x, w1, w2, w3, w4):
        B, S, D = x.shape
        h = _gelu(_layernorm(x, axis=-1) @ w1)
        c = D // 4
        g0 = _pad(h[:, :, 0*c:1*c], ((0, 0), (1, 0), (0, 0)))[:, :S, :]
        g1 = _pad(h[:, :, 1*c:2*c], ((0, 0), (0, 1), (0, 0)))[:, 1:, :]
        g2 = _pad(h[:, :, 2*c:3*c], ((0, 0), (2, 0), (0, 0)))[:, :S, :]
        g3 = _pad(h[:, :, 3*c:   ], ((0, 0), (0, 2), (0, 0)))[:, 2:, :]
        hs = torch.concatenate([g0, g1, g2, g3], axis=-1) @ w2
        x1 = x + hs
        h2 = _gelu(_layernorm(x1, axis=-1) @ w3) @ w4
        return x1 + h2

    x = A_x
    xn = _layernorm(x, axis=-1)
    s = _A_ref(xn, A_wq, A_wk, A_wv, A_wo)
    g = _silu(_B_ref(xn, B_w1, B_w2, B_w3, B_w4))
    return x + s * g
```

```asm
; @launch grid=(256,1,1) block=(512,1,1) lds=163840
.amdgcn_target "amdgcn-amd-amdhsa--gfx950"
.text
.globl recurrent_scan__grouped_kv_mqa__mixer_s_mlp__prompt_kernel
.p2align 8
.type recurrent_scan__grouped_kv_mqa__mixer_s_mlp__prompt_kernel,@function
recurrent_scan__grouped_kv_mqa__mixer_s_mlp__prompt_kernel:
    s_cmp_ge_u32 s2, 256
    s_cbranch_scc1 L_end
    s_load_dwordx16 s[40:55], s[0:1], 0
    s_load_dwordx8 s[56:63], s[0:1], 64
    s_load_dwordx2 s[64:65], s[0:1], 96
    s_memrealtime s[66:67]
    s_getpc_b64 s[82:83]
    v_lshrrev_b32 v4, 6, v0
    s_lshr_b32 s80, s2, 3
    v_readfirstlane_b32 s68, v4
    v_and_b32 v0, 63, v0
    v_lshlrev_b32 v6, 7, v0
    s_and_b32 s82, s82, 0xffffff00
    s_mul_i32 s84, s80, 26
    s_lshr_b32 s84, s84, 8
    s_mul_i32 s84, s84, 10
    s_sub_u32 s84, s80, s84
    s_lshl_b32 s84, s84, 3
    s_add_u32 s84, s84, s68
    s_lshl_b32 s84, s84, 9
    v_add_u32 v5, s84, v6
    v_min_u32 v5, L_code_end-recurrent_scan__grouped_kv_mqa__mixer_s_mlp__prompt_kernel-4, v5
    s_mov_b64 exec, 15
    global_load_dword a124, v5, s[82:83]
    s_mov_b64 exec, -1
    s_and_b32 s81, s80, 3
    s_and_b32 s70, s2, 7
    s_lshl_b32 s70, s70, 2
    s_add_u32 s70, s70, s81
    s_lshr_b32 s71, s80, 2
    v_lshlrev_b32 v1, 4, v0
    v_lshrrev_b32 v100, 3, v0
    v_lshrrev_b32 v4, 2, v0
    v_and_b32 v4, 4, v4
    v_xor_b32 v4, v4, v0
    v_and_b32 v4, 7, v4
    v_lshlrev_b32 v101, 4, v4
    s_lshl_b32 s81, s81, 1
    s_add_u32 s81, s81, s68
    s_and_b32 s81, s81, 7
    s_lshl_b32 s84, s81, 10
    s_lshl_b32 s85, s81, 3
    v_add_u32 v5, s85, v100
    s_lshl_b32 s82, s71, 7
    s_sub_u32 s82, s82, 128
    v_mul_u32_u24 v7, 896, v5
    v_add3_u32 v103, v7, v101, s82
    s_and_b32 s69, s68, 3
    s_mul_i32 s81, s69, 7168
    v_add_u32 v7, s81, v1
    s_mul_i32 s81, s68, 7168
    s_cmp_eq_u32 s71, 0
    s_cselect_b64 vcc, -1, 0
    s_cselect_b32 s81, s81, s84
    s_mov_b32 s82, 1024
    s_cselect_b32 s83, s82, 57344
    s_cselect_b32 s85, s82, 8192
    v_cndmask_b32 v103, v103, v7, vcc
    s_add_u32 m0, s81, 57344
    s_lshl_b32 s88, s70, 3
    s_add_u32 s88, s88, s71
    s_lshl_b32 s88, s88, 3
    s_add_u32 s88, s88, s68
    s_mul_i32 s88, s88, 896
    s_mul_i32 s89, s70, 7
    s_add_u32 s89, s89, s68
    s_mul_i32 s89, s89, 1792
    s_mul_i32 s80, s71, 112
    s_add_u32 s89, s89, s80
    s_cmp_eq_u32 s68, 7
    s_cselect_b32 s89, 2147418112, s89
    v_lshrrev_b32 v102, 1, v0
    v_mul_u32_u24 v102, 896, v102
    v_and_b32 v7, 1, v0
    v_mul_u32_u24 v7, 120, v7
    v_add_u32 v102, v102, v7
    s_mov_b32 s6, 1835008
    s_mov_b32 s7, 0x20000
    s_mov_b32 s14, 401408
    s_mov_b32 s15, 0x20000
    s_mov_b32 s11, 0x20000
    s_mov_b32 s10, 25088
    s_cmp_eq_u32 s71, 0
    s_cselect_b32 s10, s10, 401408
    s_mov_b32 s80, 0
    s_cmp_lt_u32 s68, 4
    s_waitcnt lgkmcnt(0)
    s_cselect_b64 s[8:9], s[44:45], s[46:47]
    s_cmp_eq_u32 s71, 0
    s_cselect_b64 s[8:9], s[8:9], s[52:53]
    s_mov_b64 s[4:5], s[40:41]
    s_mov_b64 s[12:13], s[42:43]
    s_mov_b64 exec, 0x7f
    buffer_load_dword a126, v6, s[4:7], s88 offen
    s_mov_b64 exec, 15
    buffer_load_dword a125, v102, s[12:15], s89 offen
    s_mov_b64 exec, -1
    buffer_load_dwordx4 v103, s[8:11], s80 offen lds
    s_add_u32 m0, m0, s85
    s_add_u32 s80, s80, s83
    buffer_load_dwordx4 v103, s[8:11], s80 offen lds
    s_add_u32 m0, m0, s85
    s_add_u32 s80, s80, s83
    buffer_load_dwordx4 v103, s[8:11], s80 offen lds
    s_add_u32 m0, m0, s85
    s_add_u32 s80, s80, s83
    buffer_load_dwordx4 v103, s[8:11], s80 offen lds
    s_add_u32 m0, m0, s85
    s_add_u32 s80, s80, s83
    buffer_load_dwordx4 v103, s[8:11], s80 offen lds
    s_add_u32 m0, m0, s85
    s_add_u32 s80, s80, s83
    buffer_load_dwordx4 v103, s[8:11], s80 offen lds
    s_add_u32 m0, m0, s85
    s_add_u32 s80, s80, s83
    buffer_load_dwordx4 v103, s[8:11], s80 offen lds
    s_lshl_b32 s80, s70, 6
    v_add_u32 v5, s80, v5
    v_mul_u32_u24 v6, 896, v5
    v_lshrrev_b32 v5, 1, v5
    v_xor_b32 v5, v5, v0
    v_and_b32 v5, 7, v5
    v_lshl_add_u32 v109, v5, 4, v6
    s_and_b32 s72, s68, 1
    s_lshr_b32 s73, s69, 1
    s_mov_b32 s16, s64
    s_mov_b32 s17, s65
    s_mov_b32 s18, 14680064
    s_mov_b32 s19, 0x20000
    s_mov_b32 s32, s62
    s_mov_b32 s33, s63
    s_mov_b32 s34, 256
    s_mov_b32 s35, 0x20000
    s_cmp_lg_u32 s68, 0
    s_cbranch_scc1 L_nz
    v_lshlrev_b32 v4, 2, v0
    v_add_u32 v4, 159744, v4
    v_mov_b32 v5, 0
    ds_write_b32 v4, v5
    s_waitcnt lgkmcnt(0)
    s_cmp_lg_u32 s2, 0
    s_cbranch_scc1 L_nz
    s_or_b32 s66, s66, 1
    v_mov_b32 v6, s66
    v_mov_b32 v7, s67
    s_mov_b64 exec, 1
    buffer_store_dwordx2 v[6:7], v5, s[32:35], 0 offen sc1
    s_mov_b64 exec, -1
L_nz:
    s_lshl_b32 s74, s70, 1
    s_add_u32 s74, s74, s72
    s_mov_b32 s76, 0
    s_mov_b32 s77, -1
    s_getreg_b32 s75, hwreg(HW_REG_XCC_ID, 0, 4)
    s_mov_b32 s3, 0
    v_bfe_u32 v4, v0, 2, 2
    v_lshlrev_b32 v4, 7, v4
    v_lshrrev_b32 v5, 5, v0
    v_lshl_add_u32 v2, v5, 10, v4
    v_lshl_add_u32 v3, v5, 9, v4
    v_bfe_u32 v4, v0, 4, 1
    v_and_b32 v6, 3, v0
    v_lshlrev_b32 v6, 3, v6
    v_lshl_add_u32 v103, v4, 5, v6
    v_bfe_u32 v4, v0, 3, 1
    v_lshlrev_b32 v102, 6, v4
    v_and_b32 v7, 31, v0
    s_lshl_b32 s80, s72, 5
    v_add_u32 v4, s80, v7
    v_bfe_u32 v6, v4, 1, 3
    v_lshlrev_b32 v4, 7, v4
    v_xor_b32 v6, v6, v5
    v_lshl_add_u32 v104, v6, 4, v4
    v_xor_b32 v105, 32, v104
    v_xor_b32 v106, 64, v104
    v_xor_b32 v107, 96, v104
    s_lshr_b32 s81, s68, 1
    s_lshl_b32 s80, s81, 5
    v_xor_b32 v108, s80, v104
    s_lshl_b32 s80, s72, 10
    s_add_u32 s80, s80, 161792
    v_lshl_add_u32 v110, v7, 3, s80
    s_lshl_b32 s80, s81, 8
    v_add_u32 v111, s80, v110
    v_mov_b32 v30, 0
    v_mov_b32 v31, 0
    s_mov_b32 s85, 1065369472
    v_mov_b32 v96, 1065369472
    v_mov_b32 v97, 1065369472
    v_mov_b32 v98, 1065369472
    v_mov_b32 v99, 1065369472
    s_lshl_b32 s80, s2, 3
    s_add_u32 s80, s80, s68
    s_cmp_ge_u32 s80, 392
    s_cselect_b64 s[8:9], s[56:57], s[54:55]
    s_mov_b32 s10, 401408
    s_cselect_b32 s10, 1605632, s10
    s_cselect_b32 s81, 392, 0
    s_sub_u32 s80, s80, s81
    s_lshl_b32 s96, s80, 10
    s_lshl_b32 s80, s73, 6
    v_xor_b32 v4, v103, v102
    v_xor_b32 v4, s80, v4
    v_add_u32 v4, v4, v2
    v_lshrrev_b32 v5, 7, v2
    v_mul_u32_u24 v5, 56, v5
    s_mul_i32 s80, s73, 28672
    v_add3_u32 v5, v5, v103, s80
    s_cmp_eq_u32 s71, 0
    s_cselect_b64 vcc, -1, 0
    v_cndmask_b32 v4, v4, v5, vcc
    v_add_u32 v29, 57344, v4
    s_barrier
    s_add_u32 m0, s84, 0
    s_nop 0
    buffer_load_dwordx4 v109, s[4:7], 0 offen lds
    s_add_u32 m0, s84, 8064
    s_nop 0
    buffer_load_dwordx4 v109, s[4:7], 0 offen offset:128 lds
    s_add_u32 m0, s84, 16128
    s_nop 0
    buffer_load_dwordx4 v109, s[4:7], 0 offen offset:256 lds
    s_add_u32 m0, s84, 24192
    s_nop 0
    buffer_load_dwordx4 v109, s[4:7], 0 offen offset:384 lds
    s_add_u32 m0, s84, 32256
    s_nop 0
    buffer_load_dwordx4 v109, s[4:7], 0 offen offset:512 lds
    s_add_u32 m0, s84, 40320
    s_nop 0
    buffer_load_dwordx4 v109, s[4:7], 0 offen offset:640 lds
    s_add_u32 m0, s84, 48384
    s_nop 0
    buffer_load_dwordx4 v109, s[4:7], 0 offen offset:768 lds
    s_waitcnt vmcnt(7)
    s_barrier
    s_cmp_ge_u32 s68, 4
    s_cbranch_scc1 L_att
    s_setprio 2
    s_cmp_eq_u32 s71, 0
    s_cbranch_scc1 L_cskv
    ds_read_b64_tr_b16 a[0:1], v29 offset:0
    ds_read_b64_tr_b16 a[2:3], v29 offset:512
    s_mov_b64 s[36:37], s[54:55]
    ds_read_b64_tr_b16 a[4:5], v29 offset:2048
    ds_read_b64_tr_b16 a[6:7], v29 offset:2560
    s_mov_b32 s38, 401408
    s_mov_b32 s39, 0x20000
    ds_read_b64_tr_b16 a[8:9], v29 offset:4096
    ds_read_b64_tr_b16 a[10:11], v29 offset:4608
    s_mov_b64 s[12:13], s[56:57]
    ds_read_b64_tr_b16 a[12:13], v29 offset:6144
    ds_read_b64_tr_b16 a[14:15], v29 offset:6656
    s_mov_b32 s14, 1605632
    s_mov_b32 s15, 0x20000
    ds_read_b64_tr_b16 a[16:17], v29 offset:8192
    ds_read_b64_tr_b16 a[18:19], v29 offset:8704
    s_waitcnt lgkmcnt(8)
    v_mfma_f32_32x32x16_bf16 v[48:63], a[0:3], v[96:99], 0
    s_mov_b64 s[20:21], s[58:59]
    ds_read_b64_tr_b16 a[20:21], v29 offset:10240
    ds_read_b64_tr_b16 a[22:23], v29 offset:10752
    s_waitcnt lgkmcnt(8)
    v_mfma_f32_32x32x16_bf16 v[48:63], a[4:7], v[96:99], v[48:63]
    s_mov_b32 s22, 1605632
    s_mov_b32 s23, 0x20000
    ds_read_b64_tr_b16 a[24:25], v29 offset:12288
    ds_read_b64_tr_b16 a[26:27], v29 offset:12800
    s_waitcnt lgkmcnt(8)
    v_mfma_f32_32x32x16_bf16 v[48:63], a[8:11], v[96:99], v[48:63]
    s_mov_b64 s[24:25], s[48:49]
    s_mov_b32 s26, 401408
    ds_read_b64_tr_b16 a[28:29], v29 offset:14336
    ds_read_b64_tr_b16 a[30:31], v29 offset:14848
    s_waitcnt lgkmcnt(8)
    v_mfma_f32_32x32x16_bf16 v[48:63], a[12:15], v[96:99], v[48:63]
    s_mov_b32 s27, 0x20000
    ds_read_b64_tr_b16 a[32:33], v29 offset:16384
    ds_read_b64_tr_b16 a[34:35], v29 offset:16896
    s_waitcnt lgkmcnt(8)
    v_mfma_f32_32x32x16_bf16 v[48:63], a[16:19], v[96:99], v[48:63]
    s_mov_b64 s[28:29], s[60:61]
    s_mov_b32 s30, 1835008
    ds_read_b64_tr_b16 a[36:37], v29 offset:18432
    ds_read_b64_tr_b16 a[38:39], v29 offset:18944
    s_waitcnt lgkmcnt(8)
    v_mfma_f32_32x32x16_bf16 v[48:63], a[20:23], v[96:99], v[48:63]
    s_mov_b32 s31, 0x20000
    ds_read_b64_tr_b16 a[40:41], v29 offset:20480
    ds_read_b64_tr_b16 a[42:43], v29 offset:20992
    s_waitcnt lgkmcnt(8)
    v_mfma_f32_32x32x16_bf16 v[48:63], a[24:27], v[96:99], v[48:63]
    s_max_u32 s81, s71, 1
    s_sub_u32 s81, s81, 1
    ds_read_b64_tr_b16 a[44:45], v29 offset:22528
    ds_read_b64_tr_b16 a[46:47], v29 offset:23040
    s_waitcnt lgkmcnt(8)
    v_mfma_f32_32x32x16_bf16 v[48:63], a[28:31], v[96:99], v[48:63]
    s_lshl_b32 s84, s81, 1
    s_add_u32 s84, s84, s73
    ds_read_b64_tr_b16 a[48:49], v29 offset:24576
    ds_read_b64_tr_b16 a[50:51], v29 offset:25088
    s_waitcnt lgkmcnt(8)
    v_mfma_f32_32x32x16_bf16 v[48:63], a[32:35], v[96:99], v[48:63]
    s_mul_i32 s86, s69, 14336
    ds_read_b64_tr_b16 a[52:53], v29 offset:26624
    ds_read_b64_tr_b16 a[54:55], v29 offset:27136
    s_waitcnt lgkmcnt(8)
    v_mfma_f32_32x32x16_bf16 v[48:63], a[36:39], v[96:99], v[48:63]
    s_mul_i32 s87, s69, 11264
    s_add_u32 s87, s87, 114688
    ds_read_b64_tr_b16 a[56:57], v29 offset:28672
    ds_read_b64_tr_b16 a[58:59], v29 offset:29184
    s_waitcnt lgkmcnt(8)
    v_mfma_f32_32x32x16_bf16 v[48:63], a[40:43], v[96:99], v[48:63]
    s_mul_i32 s88, s69, 100352
    ds_read_b64_tr_b16 a[60:61], v29 offset:30720
    ds_read_b64_tr_b16 a[62:63], v29 offset:31232
    s_waitcnt lgkmcnt(8)
    v_mfma_f32_32x32x16_bf16 v[48:63], a[44:47], v[96:99], v[48:63]
    s_mul_i32 s89, s69, 401408
    s_and_b32 s93, s70, 3
    ds_read_b64_tr_b16 a[64:65], v29 offset:32768
    ds_read_b64_tr_b16 a[66:67], v29 offset:33280
    s_waitcnt lgkmcnt(8)
    v_mfma_f32_32x32x16_bf16 v[48:63], a[48:51], v[96:99], v[48:63]
    s_lshl_b32 s93, s93, 1
    s_add_u32 s93, s93, s71
    ds_read_b64_tr_b16 a[68:69], v29 offset:34816
    ds_read_b64_tr_b16 a[70:71], v29 offset:35328
    s_waitcnt lgkmcnt(8)
    v_mfma_f32_32x32x16_bf16 v[48:63], a[52:55], v[96:99], v[48:63]
    s_cmp_ge_u32 s93, 7
    ds_read_b64_tr_b16 a[72:73], v29 offset:36864
    ds_read_b64_tr_b16 a[74:75], v29 offset:37376
    s_waitcnt lgkmcnt(8)
    v_mfma_f32_32x32x16_bf16 v[48:63], a[56:59], v[96:99], v[48:63]
    s_cselect_b32 s80, 7, 0
    s_sub_u32 s93, s93, s80
    ds_read_b64_tr_b16 a[76:77], v29 offset:38912
    ds_read_b64_tr_b16 a[78:79], v29 offset:39424
    s_waitcnt lgkmcnt(8)
    v_mfma_f32_32x32x16_bf16 v[48:63], a[60:63], v[96:99], v[48:63]
    v_mul_u32_u24 v4, 896, v100
    ds_read_b64_tr_b16 a[80:81], v29 offset:40960
    ds_read_b64_tr_b16 a[82:83], v29 offset:41472
    s_waitcnt lgkmcnt(8)
    v_mfma_f32_32x32x16_bf16 v[48:63], a[64:67], v[96:99], v[48:63]
    s_lshl_b32 s80, s81, 7
    v_add3_u32 v24, v4, v101, s80
    ds_read_b64_tr_b16 a[84:85], v29 offset:43008
    ds_read_b64_tr_b16 a[86:87], v29 offset:43520
    s_waitcnt lgkmcnt(8)
    v_mfma_f32_32x32x16_bf16 v[48:63], a[68:71], v[96:99], v[48:63]
    v_mul_u32_u24 v4, 3584, v100
    s_lshl_b32 s80, s81, 9
    ds_read_b64_tr_b16 a[88:89], v29 offset:45056
    ds_read_b64_tr_b16 a[90:91], v29 offset:45568
    s_waitcnt lgkmcnt(8)
    v_mfma_f32_32x32x16_bf16 v[48:63], a[72:75], v[96:99], v[48:63]
    s_lshl_b32 s82, s69, 7
    ds_read_b64_tr_b16 a[92:93], v29 offset:47104
    ds_read_b64_tr_b16 a[94:95], v29 offset:47616
    s_waitcnt lgkmcnt(8)
    v_mfma_f32_32x32x16_bf16 v[48:63], a[76:79], v[96:99], v[48:63]
    s_add_u32 s80, s80, s82
    v_add3_u32 v26, v4, v101, s80
    ds_read_b64_tr_b16 a[96:97], v29 offset:49152
    ds_read_b64_tr_b16 a[98:99], v29 offset:49664
    s_waitcnt lgkmcnt(8)
    v_mfma_f32_32x32x16_bf16 v[48:63], a[80:83], v[96:99], v[48:63]
    s_lshl_b32 s80, s73, 6
    ds_read_b64_tr_b16 a[100:101], v29 offset:51200
    ds_read_b64_tr_b16 a[102:103], v29 offset:51712
    s_waitcnt lgkmcnt(8)
    v_mfma_f32_32x32x16_bf16 v[48:63], a[84:87], v[96:99], v[48:63]
    v_xor_b32 v103, v103, v102
    v_xor_b32 v102, s80, v103
    ds_read_b64_tr_b16 a[104:105], v29 offset:53248
    ds_read_b64_tr_b16 a[106:107], v29 offset:53760
    s_waitcnt lgkmcnt(8)
    v_mfma_f32_32x32x16_bf16 v[48:63], a[88:91], v[96:99], v[48:63]
    s_lshl_b32 s83, s81, 13
    v_lshrrev_b32 v5, 5, v0
    ds_read_b64_tr_b16 a[108:109], v29 offset:55296
    ds_read_b64_tr_b16 a[110:111], v29 offset:55808
    s_waitcnt lgkmcnt(8)
    v_mfma_f32_32x32x16_bf16 v[48:63], a[92:95], v[96:99], v[48:63]
    v_lshlrev_b32 v6, 4, v5
    s_waitcnt lgkmcnt(6)
    v_mfma_f32_32x32x16_bf16 v[48:63], a[96:99], v[96:99], v[48:63]
    v_xor_b32 v124, v104, v6
    v_xor_b32 v124, s80, v124
    s_waitcnt lgkmcnt(4)
    v_mfma_f32_32x32x16_bf16 v[48:63], a[100:103], v[96:99], v[48:63]
    v_lshl_add_u32 v124, v5, 3, v124
    s_waitcnt lgkmcnt(2)
    v_mfma_f32_32x32x16_bf16 v[48:63], a[104:107], v[96:99], v[48:63]
    v_add_u32 v124, s83, v124
    v_xor_b32 v125, 16, v124
    s_waitcnt lgkmcnt(0)
    v_mfma_f32_32x32x16_bf16 v[48:63], a[108:111], v[96:99], v[48:63]
    v_xor_b32 v126, 32, v124
    v_xor_b32 v127, 48, v124
L_csdone:
    s_waitcnt vmcnt(0)
    s_barrier
    ds_read_b128 v[16:19], v108 offset:0
    ds_read_b128 v[20:23], v108 offset:8192
    ds_read_b128 v[88:91], v108 offset:16384
    ds_read_b128 v[92:95], v108 offset:24576
    ds_read_b128 v[112:115], v108 offset:32768
    ds_read_b128 v[116:119], v108 offset:40960
    ds_read_b128 v[120:123], v108 offset:49152
    ds_read_b128 v[64:67], v104 offset:0
    ds_read_b128 v[68:71], v105 offset:0
    ds_read_b128 v[72:75], v106 offset:0
    ds_read_b128 v[76:79], v107 offset:0
    ds_read_b128 v[80:83], v104 offset:8192
    ds_read_b64 v[8:9], v124
    ds_read_b64 v[10:11], v125
    ds_read_b64 v[12:13], v126
    ds_read_b64 v[14:15], v127
    s_waitcnt lgkmcnt(15)
    v_dot2c_f32_bf16 v30, s85, v16
    v_dot2c_f32_bf16 v31, v16, v16
    v_dot2c_f32_bf16 v30, s85, v17
    v_dot2c_f32_bf16 v31, v17, v17
    v_dot2c_f32_bf16 v30, s85, v18
    v_dot2c_f32_bf16 v31, v18, v18
    v_dot2c_f32_bf16 v30, s85, v19
    v_dot2c_f32_bf16 v31, v19, v19
    s_waitcnt lgkmcnt(14)
    v_dot2c_f32_bf16 v30, s85, v20
    v_dot2c_f32_bf16 v31, v20, v20
    v_dot2c_f32_bf16 v30, s85, v21
    v_dot2c_f32_bf16 v31, v21, v21
    v_dot2c_f32_bf16 v30, s85, v22
    v_dot2c_f32_bf16 v31, v22, v22
    v_dot2c_f32_bf16 v30, s85, v23
    v_dot2c_f32_bf16 v31, v23, v23
    s_waitcnt lgkmcnt(13)
    v_dot2c_f32_bf16 v30, s85, v88
    v_dot2c_f32_bf16 v31, v88, v88
    v_dot2c_f32_bf16 v30, s85, v89
    v_dot2c_f32_bf16 v31, v89, v89
    v_dot2c_f32_bf16 v30, s85, v90
    v_dot2c_f32_bf16 v31, v90, v90
    v_dot2c_f32_bf16 v30, s85, v91
    v_dot2c_f32_bf16 v31, v91, v91
    s_waitcnt lgkmcnt(12)
    v_dot2c_f32_bf16 v30, s85, v92
    v_dot2c_f32_bf16 v31, v92, v92
    v_dot2c_f32_bf16 v30, s85, v93
    v_dot2c_f32_bf16 v31, v93, v93
    v_dot2c_f32_bf16 v30, s85, v94
    v_dot2c_f32_bf16 v31, v94, v94
    v_dot2c_f32_bf16 v30, s85, v95
    v_dot2c_f32_bf16 v31, v95, v95
    s_waitcnt lgkmcnt(11)
    v_dot2c_f32_bf16 v30, s85, v112
    v_dot2c_f32_bf16 v31, v112, v112
    v_dot2c_f32_bf16 v30, s85, v113
    v_dot2c_f32_bf16 v31, v113, v113
    v_dot2c_f32_bf16 v30, s85, v114
    v_dot2c_f32_bf16 v31, v114, v114
    v_dot2c_f32_bf16 v30, s85, v115
    v_dot2c_f32_bf16 v31, v115, v115
    s_waitcnt lgkmcnt(10)
    v_dot2c_f32_bf16 v30, s85, v116
    v_dot2c_f32_bf16 v31, v116, v116
    v_dot2c_f32_bf16 v30, s85, v117
    v_dot2c_f32_bf16 v31, v117, v117
    v_dot2c_f32_bf16 v30, s85, v118
    v_dot2c_f32_bf16 v31, v118, v118
    v_dot2c_f32_bf16 v30, s85, v119
    v_dot2c_f32_bf16 v31, v119, v119
    s_waitcnt lgkmcnt(9)
    v_dot2c_f32_bf16 v30, s85, v120
    v_dot2c_f32_bf16 v31, v120, v120
    v_dot2c_f32_bf16 v30, s85, v121
    v_dot2c_f32_bf16 v31, v121, v121
    v_dot2c_f32_bf16 v30, s85, v122
    v_dot2c_f32_bf16 v31, v122, v122
    v_dot2c_f32_bf16 v30, s85, v123
    v_dot2c_f32_bf16 v31, v123, v123
    s_nop 2
    v_mov_b32 v6, v30
    s_nop 1
    v_permlane32_swap_b32 v30, v6
    v_mov_b32 v7, v31
    s_nop 1
    v_permlane32_swap_b32 v31, v7
    v_add_f32 v30, v30, v6
    v_add_f32 v31, v31, v7
    ds_write_b64 v111, v[30:31]
    s_waitcnt lgkmcnt(0)
    s_barrier
    s_lshl_b32 s83, s69, 13
    ds_read_b128 v[84:87], v105 offset:8192
    ds_read_b64 v[112:113], v110 offset:0
    ds_read_b64 v[114:115], v110 offset:256
    ds_read_b64 v[116:117], v110 offset:512
    ds_read_b64 v[118:119], v110 offset:768
    v_mov_b32 v7, 0
    buffer_load_dwordx2 v[30:31], v7, s[32:35], 0 offen sc1
    v_mfma_f32_32x32x16_bf16 v[32:47], a[0:3], v[64:67], 0
    ds_read_b128 v[64:67], v106 offset:8192
    v_mfma_f32_32x32x16_bf16 v[32:47], a[4:7], v[68:71], v[32:47]
    v_lshlrev_b32 v4, 7, v0
    s_mov_b64 exec, 255
    buffer_load_dword a127, v4, s[8:11], s96 offen
    s_mov_b64 exec, -1
    ds_read_b128 v[68:71], v107 offset:8192
    v_mfma_f32_32x32x16_bf16 v[32:47], a[8:11], v[72:75], v[32:47]
    ds_read_b128 v[72:75], v104 offset:16384
    v_mfma_f32_32x32x16_bf16 v[32:47], a[12:15], v[76:79], v[32:47]
    ds_read_b128 v[76:79], v105 offset:16384
    v_mfma_f32_32x32x16_bf16 v[32:47], a[16:19], v[80:83], v[32:47]
    ds_read_b128 v[80:83], v106 offset:16384
    s_waitcnt lgkmcnt(9)
    v_mfma_f32_32x32x16_bf16 v[32:47], a[20:23], v[84:87], v[32:47]
    s_waitcnt lgkmcnt(5)
    v_add_f32 v112, v112, v114
    v_add_f32 v113, v113, v115
    v_add_f32 v116, v116, v118
    ds_read_b128 v[84:87], v107 offset:16384
    s_waitcnt lgkmcnt(5)
    v_mfma_f32_32x32x16_bf16 v[32:47], a[24:27], v[64:67], v[32:47]
    v_add_f32 v117, v117, v119
    v_add_f32 v112, v112, v116
    v_add_f32 v113, v113, v117
    ds_read_b128 v[64:67], v104 offset:24576
    s_waitcnt lgkmcnt(5)
    v_mfma_f32_32x32x16_bf16 v[32:47], a[28:31], v[68:71], v[32:47]
    v_mul_f32 v27, 0x3b124925, v112
    v_mul_f32 v112, v27, v27
    v_mul_f32 v113, 0x3b124925, v113
    ds_read_b128 v[68:71], v105 offset:24576
    s_waitcnt lgkmcnt(5)
    v_mfma_f32_32x32x16_bf16 v[32:47], a[32:35], v[72:75], v[32:47]
    v_sub_f32 v113, v113, v112
    v_max_f32 v28, 0, v113
    v_add_f32 v4, 0x3727c5ac, v28
    ds_read_b128 v[72:75], v106 offset:24576
    s_waitcnt lgkmcnt(5)
    v_mfma_f32_32x32x16_bf16 v[32:47], a[36:39], v[76:79], v[32:47]
    v_rsq_f32 v5, v4
    v_mov_b32 v7, 0x3727c5ac
    v_mul_f32 v6, v5, v5
    ds_read_b128 v[76:79], v107 offset:24576
    s_waitcnt lgkmcnt(5)
    v_mfma_f32_32x32x16_bf16 v[32:47], a[40:43], v[80:83], v[32:47]
    v_fma_f32 v6, v6, v28, v7
    v_rsq_f32 v6, v6
    v_mov_b32 v28, v5
    ds_read_b128 v[80:83], v104 offset:32768
    s_waitcnt lgkmcnt(5)
    v_mfma_f32_32x32x16_bf16 v[32:47], a[44:47], v[84:87], v[32:47]
    v_mul_f32 v123, v5, v6
    v_rcp_f32 v122, v123
    v_mul_f32 v120, 0xc0135761, v123
    ds_read_b128 v[84:87], v105 offset:32768
    s_waitcnt lgkmcnt(5)
    v_mfma_f32_32x32x16_bf16 v[32:47], a[48:51], v[64:67], v[32:47]
    v_mul_f32 v121, v123, v123
    v_mul_f32 v121, v121, v123
    v_mul_f32 v121, 0xbdd2d3e8, v121
    ds_read_b128 v[64:67], v106 offset:32768
    s_waitcnt lgkmcnt(5)
    v_mfma_f32_32x32x16_bf16 v[32:47], a[52:55], v[68:71], v[32:47]
    v_mul_f32 v48, v48, v27
    v_mul_f32 v49, v49, v27
    v_mul_f32 v50, v50, v27
    ds_read_b128 v[68:71], v107 offset:32768
    s_waitcnt lgkmcnt(5)
    v_mfma_f32_32x32x16_bf16 v[32:47], a[56:59], v[72:75], v[32:47]
    v_mul_f32 v51, v51, v27
    v_mul_f32 v52, v52, v27
    v_mul_f32 v53, v53, v27
    ds_read_b128 v[72:75], v104 offset:40960
    s_waitcnt lgkmcnt(5)
    v_mfma_f32_32x32x16_bf16 v[32:47], a[60:63], v[76:79], v[32:47]
    v_mul_f32 v54, v54, v27
    v_mul_f32 v55, v55, v27
    v_mul_f32 v56, v56, v27
    ds_read_b128 v[76:79], v105 offset:40960
    s_waitcnt lgkmcnt(5)
    v_mfma_f32_32x32x16_bf16 v[32:47], a[64:67], v[80:83], v[32:47]
    v_mul_f32 v57, v57, v27
    v_mul_f32 v58, v58, v27
    v_mul_f32 v59, v59, v27
    ds_read_b128 v[80:83], v106 offset:40960
    s_waitcnt lgkmcnt(5)
    v_mfma_f32_32x32x16_bf16 v[32:47], a[68:71], v[84:87], v[32:47]
    v_mul_f32 v60, v60, v27
    v_mul_f32 v61, v61, v27
    v_mul_f32 v62, v62, v27
    ds_read_b128 v[84:87], v107 offset:40960
    s_waitcnt lgkmcnt(5)
    v_mfma_f32_32x32x16_bf16 v[32:47], a[72:75], v[64:67], v[32:47]
    v_mul_f32 v63, v63, v27
    ds_read_b128 v[64:67], v104 offset:49152
    s_waitcnt lgkmcnt(5)
    v_mfma_f32_32x32x16_bf16 v[32:47], a[76:79], v[68:71], v[32:47]
    ds_read_b128 v[68:71], v105 offset:49152
    s_waitcnt lgkmcnt(5)
    v_mfma_f32_32x32x16_bf16 v[32:47], a[80:83], v[72:75], v[32:47]
    ds_read_b128 v[72:75], v106 offset:49152
    s_waitcnt lgkmcnt(5)
    v_mfma_f32_32x32x16_bf16 v[32:47], a[84:87], v[76:79], v[32:47]
    ds_read_b128 v[76:79], v107 offset:49152
    s_waitcnt lgkmcnt(5)
    v_mfma_f32_32x32x16_bf16 v[32:47], a[88:91], v[80:83], v[32:47]
    s_waitcnt lgkmcnt(4)
    v_mfma_f32_32x32x16_bf16 v[32:47], a[92:95], v[84:87], v[32:47]
    s_waitcnt lgkmcnt(3)
    v_mfma_f32_32x32x16_bf16 v[32:47], a[96:99], v[64:67], v[32:47]
    s_waitcnt lgkmcnt(2)
    v_mfma_f32_32x32x16_bf16 v[32:47], a[100:103], v[68:71], v[32:47]
    s_waitcnt lgkmcnt(1)
    v_mfma_f32_32x32x16_bf16 v[32:47], a[104:107], v[72:75], v[32:47]
    s_waitcnt lgkmcnt(0)
    v_mfma_f32_32x32x16_bf16 v[32:47], a[108:111], v[76:79], v[32:47]
    s_mov_b64 exec, 1
    v_mov_b32 v4, 159744
    v_mov_b32 v5, 1
    ds_add_u32 v4, v5
    s_mov_b64 exec, -1
    s_cmp_eq_u32 s71, 0
    s_cbranch_scc1 L_kv
    s_nop 4
    v_sub_f32 v32, v32, v48
    v_sub_f32 v33, v33, v49
    v_sub_f32 v34, v34, v50
    v_sub_f32 v35, v35, v51
    v_sub_f32 v36, v36, v52
    v_sub_f32 v37, v37, v53
    v_sub_f32 v38, v38, v54
    v_sub_f32 v39, v39, v55
    v_sub_f32 v40, v40, v56
    v_sub_f32 v41, v41, v57
    v_sub_f32 v42, v42, v58
    v_sub_f32 v43, v43, v59
    v_sub_f32 v44, v44, v60
    v_sub_f32 v45, v45, v61
    v_sub_f32 v46, v46, v62
    v_sub_f32 v47, v47, v63
    v_mul_f32 v72, v32, v32
    v_mul_f32 v73, v33, v33
    v_fma_f32 v72, v72, v121, v120
    v_fma_f32 v73, v73, v121, v120
    v_mul_f32 v72, v72, v32
    v_mul_f32 v73, v73, v33
    v_exp_f32 v72, v72
    v_exp_f32 v73, v73
    v_fma_f32 v72, v72, v122, v122
    v_fma_f32 v73, v73, v122, v122
    v_rcp_f32 v72, v72
    v_rcp_f32 v73, v73
    v_mul_f32 v72, v72, v32
    v_mul_f32 v73, v73, v33
    v_cvt_pk_bf16_f32 v64, v72, v73
    v_mul_f32 v72, v34, v34
    v_mul_f32 v73, v35, v35
    v_fma_f32 v72, v72, v121, v120
    v_fma_f32 v73, v73, v121, v120
    v_mul_f32 v72, v72, v34
    v_mul_f32 v73, v73, v35
    v_exp_f32 v72, v72
    v_exp_f32 v73, v73
    v_fma_f32 v72, v72, v122, v122
    v_fma_f32 v73, v73, v122, v122
    v_rcp_f32 v72, v72
    v_rcp_f32 v73, v73
    v_mul_f32 v72, v72, v34
    v_mul_f32 v73, v73, v35
    v_cvt_pk_bf16_f32 v65, v72, v73
    v_mul_f32 v72, v36, v36
    v_mul_f32 v73, v37, v37
    v_fma_f32 v72, v72, v121, v120
    v_fma_f32 v73, v73, v121, v120
    v_mul_f32 v72, v72, v36
    v_mul_f32 v73, v73, v37
    v_exp_f32 v72, v72
    v_exp_f32 v73, v73
    v_fma_f32 v72, v72, v122, v122
    v_fma_f32 v73, v73, v122, v122
    v_rcp_f32 v72, v72
    v_rcp_f32 v73, v73
    v_mul_f32 v72, v72, v36
    v_mul_f32 v73, v73, v37
    v_cvt_pk_bf16_f32 v66, v72, v73
    v_and_b32 v4, 31, v0
    s_lshl_b32 s80, s74, 5
    v_add_u32 v4, s80, v4
    v_lshrrev_b32 v5, 5, v0
    v_lshlrev_b32 v5, 15, v5
    v_lshl_add_u32 v74, v4, 4, v5
    s_lshl_b32 s80, s84, 17
    s_add_u32 s80, s80, 1048576
    s_add_u32 s81, s80, 0x10000
    v_mul_f32 v72, v38, v38
    v_mul_f32 v73, v39, v39
    v_fma_f32 v72, v72, v121, v120
    v_fma_f32 v73, v73, v121, v120
    v_mul_f32 v72, v72, v38
    v_mul_f32 v73, v73, v39
    v_exp_f32 v72, v72
    v_exp_f32 v73, v73
    v_fma_f32 v72, v72, v122, v122
    v_fma_f32 v73, v73, v122, v122
    v_rcp_f32 v72, v72
    v_rcp_f32 v73, v73
    v_mul_f32 v72, v72, v38
    v_mul_f32 v73, v73, v39
    v_cvt_pk_bf16_f32 v67, v72, v73
    buffer_store_dwordx4 v[64:67], v74, s[16:19], s80 offen sc1
    v_mul_f32 v72, v40, v40
    v_mul_f32 v73, v41, v41
    v_fma_f32 v72, v72, v121, v120
    v_fma_f32 v73, v73, v121, v120
    v_mul_f32 v72, v72, v40
    v_mul_f32 v73, v73, v41
    v_exp_f32 v72, v72
    v_exp_f32 v73, v73
    v_fma_f32 v72, v72, v122, v122
    v_fma_f32 v73, v73, v122, v122
    v_rcp_f32 v72, v72
    v_rcp_f32 v73, v73
    v_mul_f32 v72, v72, v40
    v_mul_f32 v73, v73, v41
    v_cvt_pk_bf16_f32 v68, v72, v73
    v_mul_f32 v72, v42, v42
    v_mul_f32 v73, v43, v43
    v_fma_f32 v72, v72, v121, v120
    v_fma_f32 v73, v73, v121, v120
    v_mul_f32 v72, v72, v42
    v_mul_f32 v73, v73, v43
    v_exp_f32 v72, v72
    v_exp_f32 v73, v73
    v_fma_f32 v72, v72, v122, v122
    v_fma_f32 v73, v73, v122, v122
    v_rcp_f32 v72, v72
    v_rcp_f32 v73, v73
    v_mul_f32 v72, v72, v42
    v_mul_f32 v73, v73, v43
    v_cvt_pk_bf16_f32 v69, v72, v73
    v_mul_f32 v72, v44, v44
    v_mul_f32 v73, v45, v45
    v_fma_f32 v72, v72, v121, v120
    v_fma_f32 v73, v73, v121, v120
    v_mul_f32 v72, v72, v44
    v_mul_f32 v73, v73, v45
    v_exp_f32 v72, v72
    v_exp_f32 v73, v73
    v_fma_f32 v72, v72, v122, v122
    v_fma_f32 v73, v73, v122, v122
    v_rcp_f32 v72, v72
    v_rcp_f32 v73, v73
    v_mul_f32 v72, v72, v44
    v_mul_f32 v73, v73, v45
    v_cvt_pk_bf16_f32 v70, v72, v73
    v_mul_f32 v72, v46, v46
    v_mul_f32 v73, v47, v47
    v_fma_f32 v72, v72, v121, v120
    v_fma_f32 v73, v73, v121, v120
    v_mul_f32 v72, v72, v46
    v_mul_f32 v73, v73, v47
    v_exp_f32 v72, v72
    v_exp_f32 v73, v73
    v_fma_f32 v72, v72, v122, v122
    v_fma_f32 v73, v73, v122, v122
    v_rcp_f32 v72, v72
    v_rcp_f32 v73, v73
    v_mul_f32 v72, v72, v46
    v_mul_f32 v73, v73, v47
    v_cvt_pk_bf16_f32 v71, v72, v73
    buffer_store_dwordx4 v[68:71], v74, s[16:19], s81 offen sc1
    v_mov_b32 v4, 159744
    s_mov_b32 s90, 0
L_ls_1:
    ds_read_b32 v5, v4
    s_add_u32 s90, s90, 1
    s_waitcnt lgkmcnt(0)
    v_readfirstlane_b32 s100, v5
    s_cmp_ge_u32 s100, 8
    s_cbranch_scc1 L_lk_2
    s_cmp_lt_u32 s90, 400000
    s_cbranch_scc1 L_ls_1
L_lk_2:
    s_add_u32 m0, s86, 0
    s_add_u32 s80, s88, 0
    buffer_load_dwordx4 v24, s[36:39], s80 offen lds
    s_add_u32 m0, s86, 1024
    s_add_u32 s80, s88, 7168
    buffer_load_dwordx4 v24, s[36:39], s80 offen lds
    s_add_u32 m0, s86, 2048
    s_add_u32 s80, s88, 14336
    buffer_load_dwordx4 v24, s[36:39], s80 offen lds
    s_add_u32 m0, s86, 3072
    s_add_u32 s80, s88, 21504
    buffer_load_dwordx4 v24, s[36:39], s80 offen lds
    s_add_u32 m0, s86, 4096
    s_add_u32 s80, s88, 28672
    buffer_load_dwordx4 v24, s[36:39], s80 offen lds
    s_add_u32 m0, s86, 5120
    s_add_u32 s80, s88, 35840
    buffer_load_dwordx4 v24, s[36:39], s80 offen lds
    s_add_u32 m0, s86, 6144
    s_add_u32 s80, s88, 43008
    buffer_load_dwordx4 v24, s[36:39], s80 offen lds
    s_add_u32 m0, s86, 7168
    s_add_u32 s80, s88, 50176
    buffer_load_dwordx4 v24, s[36:39], s80 offen lds
    s_add_u32 m0, s86, 8192
    s_add_u32 s80, s88, 57344
    buffer_load_dwordx4 v24, s[36:39], s80 offen lds
    s_add_u32 m0, s86, 9216
    s_add_u32 s80, s88, 64512
    buffer_load_dwordx4 v24, s[36:39], s80 offen lds
    s_add_u32 m0, s86, 10240
    s_add_u32 s80, s88, 71680
    buffer_load_dwordx4 v24, s[36:39], s80 offen lds
    s_add_u32 m0, s86, 11264
    s_add_u32 s80, s88, 78848
    buffer_load_dwordx4 v24, s[36:39], s80 offen lds
    s_add_u32 m0, s86, 12288
    s_add_u32 s80, s88, 86016
    buffer_load_dwordx4 v24, s[36:39], s80 offen lds
    s_add_u32 m0, s86, 13312
    s_add_u32 s80, s88, 93184
    buffer_load_dwordx4 v24, s[36:39], s80 offen lds
    s_waitcnt vmcnt(17)
    s_mov_b32 s90, 0
    v_mov_b32 v7, 0
L_ns_3:
    v_readfirstlane_b32 s66, v30
    v_readfirstlane_b32 s67, v31
    s_add_u32 s90, s90, 1
    s_cmp_lg_u64 s[66:67], 0
    s_cbranch_scc1 L_nk_4
    s_cmp_ge_u32 s90, 20000
    s_cbranch_scc1 L_nk_4
    buffer_load_dwordx2 v[30:31], v7, s[32:35], 0 offen sc1
    s_waitcnt vmcnt(0)
    s_branch L_ns_3
L_nk_4:
    s_waitcnt vmcnt(14)
    s_mov_b64 exec, 1
    v_mov_b32 v4, 159796
    v_mov_b32 v5, 1
    ds_add_rtn_u32 v5, v4, v5
    s_lshl_b32 s80, s70, 3
    s_add_u32 s80, s80, s71
    s_lshl_b32 s80, s80, 7
    s_add_u32 s80, s80, 327680
    s_waitcnt lgkmcnt(0)
    v_readfirstlane_b32 s81, v5
    s_cmp_lg_u32 s81, 3
    s_cbranch_scc1 L_sg_5
    s_mov_b64 exec, 255
    v_mov_b32 v4, s66
    v_mov_b32 v5, s67
    v_mov_b32 v6, s75
    buffer_store_dwordx4 v[4:7], v1, s[16:19], s80 offen sc1
L_sg_5:
    s_mov_b64 exec, -1
    s_nop 0
    s_add_u32 s80, s83, 81920
    v_add3_u32 v32, v3, v102, s80
    v_xor_b32 v33, 64, v32
    v_add_u32 v4, s86, v3
    v_add_u32 v5, s87, v3
    v_add_u32 v2, v4, v102
    v_xor_b32 v3, 64, v2
    v_add_u32 v25, v5, v102
    v_xor_b32 v31, 64, v25
    s_waitcnt vmcnt(0)
    ds_read_b64_tr_b16 a[0:1], v2 offset:0
    ds_read_b64_tr_b16 a[2:3], v2 offset:1024
    ds_read_b64_tr_b16 a[4:5], v3 offset:0
    ds_read_b64_tr_b16 a[6:7], v3 offset:1024
    ds_read_b64_tr_b16 a[8:9], v2 offset:2048
    ds_read_b64_tr_b16 a[10:11], v2 offset:3072
    ds_read_b64_tr_b16 a[12:13], v3 offset:2048
    ds_read_b64_tr_b16 a[14:15], v3 offset:3072
    ds_read_b64_tr_b16 a[16:17], v2 offset:4096
    ds_read_b64_tr_b16 a[18:19], v2 offset:5120
    ds_read_b64_tr_b16 a[20:21], v3 offset:4096
    ds_read_b64_tr_b16 a[22:23], v3 offset:5120
    ds_read_b64_tr_b16 a[24:25], v2 offset:6144
    ds_read_b64_tr_b16 a[26:27], v2 offset:7168
    ds_read_b64_tr_b16 a[28:29], v3 offset:6144
    ds_read_b64_tr_b16 a[30:31], v3 offset:7168
    ds_read_b64_tr_b16 a[32:33], v2 offset:8192
    ds_read_b64_tr_b16 a[34:35], v2 offset:9216
    ds_read_b64_tr_b16 a[36:37], v3 offset:8192
    ds_read_b64_tr_b16 a[38:39], v3 offset:9216
    ds_read_b64_tr_b16 a[40:41], v2 offset:10240
    ds_read_b64_tr_b16 a[42:43], v2 offset:11264
    ds_read_b64_tr_b16 a[44:45], v3 offset:10240
    ds_read_b64_tr_b16 a[46:47], v3 offset:11264
    ds_read_b64_tr_b16 a[48:49], v2 offset:12288
    ds_read_b64_tr_b16 a[50:51], v2 offset:13312
    ds_read_b64_tr_b16 a[52:53], v3 offset:12288
    ds_read_b64_tr_b16 a[54:55], v3 offset:13312
    s_add_u32 s80, s73, 1
    s_sub_u32 s81, 0, s80
    s_cmp_eq_u32 s72, 0
    s_cselect_b32 s80, s81, s80
    s_lshl_b32 s81, s74, 5
    s_add_u32 s81, s81, s80
    s_xor_b32 s82, s74, 1
    s_lshl_b32 s82, s82, 5
    s_add_u32 s82, s82, s80
    v_and_b32 v4, 31, v0
    v_lshrrev_b32 v5, 5, v0
    v_lshlrev_b32 v5, 15, v5
    v_mov_b32 v7, 2147418112
    v_add_u32 v6, s81, v4
    v_cmp_gt_u32 vcc, 2048, v6
    v_lshl_add_u32 v6, v6, 4, v5
    s_nop 0
    v_cndmask_b32 v29, v7, v6, vcc
    v_add_u32 v6, s82, v4
    v_cmp_gt_u32 vcc, 2048, v6
    v_lshl_add_u32 v6, v6, 4, v5
    s_nop 0
    v_cndmask_b32 v30, v7, v6, vcc
    s_lshl_b32 s80, s73, 6
    v_xor_b32 v2, s80, v2
    v_xor_b32 v3, s80, v3
    v_xor_b32 v25, s80, v25
    v_xor_b32 v31, s80, v31
    s_waitcnt lgkmcnt(0)
    s_mov_b64 exec, 1
    v_mov_b32 v4, 159748
    v_mov_b32 v5, 1
    ds_add_u32 v4, v5
    s_mov_b64 exec, -1
    s_mul_i32 s96, s93, 229376
    s_add_u32 m0, s86, 0
    s_add_u32 s80, s96, 0
    buffer_load_dwordx4 v26, s[12:15], s80 offen lds
    s_add_u32 m0, s86, 1024
    s_add_u32 s80, s96, 28672
    buffer_load_dwordx4 v26, s[12:15], s80 offen lds
    s_add_u32 m0, s86, 2048
    s_add_u32 s80, s96, 57344
    buffer_load_dwordx4 v26, s[12:15], s80 offen lds
    s_add_u32 m0, s86, 3072
    s_add_u32 s80, s96, 86016
    buffer_load_dwordx4 v26, s[12:15], s80 offen lds
    s_add_u32 m0, s86, 4096
    s_add_u32 s80, s96, 114688
    buffer_load_dwordx4 v26, s[12:15], s80 offen lds
    s_add_u32 m0, s86, 5120
    s_add_u32 s80, s96, 143360
    buffer_load_dwordx4 v26, s[12:15], s80 offen lds
    v_mul_f32 v27, v27, v28
    v_lshlrev_b32 v88, 16, v8
    v_and_b32 v89, 0xffff0000, v8
    v_fma_f32 v104, v88, v28, -v27
    v_fma_f32 v105, v89, v28, -v27
    v_lshlrev_b32 v88, 16, v9
    v_and_b32 v89, 0xffff0000, v9
    v_fma_f32 v106, v88, v28, -v27
    v_fma_f32 v107, v89, v28, -v27
    v_lshlrev_b32 v88, 16, v10
    v_and_b32 v89, 0xffff0000, v10
    v_fma_f32 v108, v88, v28, -v27
    v_fma_f32 v109, v89, v28, -v27
    v_lshlrev_b32 v88, 16, v11
    v_and_b32 v89, 0xffff0000, v11
    v_fma_f32 v110, v88, v28, -v27
    v_fma_f32 v111, v89, v28, -v27
    v_lshlrev_b32 v88, 16, v12
    v_and_b32 v89, 0xffff0000, v12
    v_fma_f32 v112, v88, v28, -v27
    v_fma_f32 v113, v89, v28, -v27
    v_lshlrev_b32 v88, 16, v13
    v_and_b32 v89, 0xffff0000, v13
    v_fma_f32 v114, v88, v28, -v27
    v_fma_f32 v115, v89, v28, -v27
    v_lshlrev_b32 v88, 16, v14
    v_and_b32 v89, 0xffff0000, v14
    v_fma_f32 v116, v88, v28, -v27
    v_fma_f32 v117, v89, v28, -v27
    v_lshlrev_b32 v88, 16, v15
    v_and_b32 v89, 0xffff0000, v15
    v_fma_f32 v118, v88, v28, -v27
    v_fma_f32 v119, v89, v28, -v27
    s_xor_b32 s80, s69, 0
    s_mul_i32 s80, s80, 14336
    s_add_u32 s80, s80, 57344
    v_add_u32 v120, s80, v1
    s_xor_b32 s80, s69, 1
    s_mul_i32 s80, s80, 14336
    s_add_u32 s80, s80, 57344
    v_add_u32 v121, s80, v1
    s_xor_b32 s80, s69, 2
    s_mul_i32 s80, s80, 14336
    s_add_u32 s80, s80, 57344
    v_add_u32 v122, s80, v1
    s_xor_b32 s80, s69, 3
    s_mul_i32 s80, s80, 14336
    s_add_u32 s80, s80, 57344
    v_add_u32 v123, s80, v1
    v_mov_b32 v4, 159748
    s_mov_b32 s90, 0
L_ls_6:
    ds_read_b32 v5, v4
    s_add_u32 s90, s90, 1
    s_waitcnt lgkmcnt(0)
    v_readfirstlane_b32 s100, v5
    s_cmp_ge_u32 s100, 4
    s_cbranch_scc1 L_lk_7
    s_cmp_lt_u32 s90, 400000
    s_cbranch_scc1 L_ls_6
L_lk_7:
    s_cmp_lg_u32 s69, 0
    s_cbranch_scc1 L_gw_10
    v_lshrrev_b32 v4, 3, v0
    s_sub_u32 s80, s70, 1
    v_add_u32 v4, s80, v4
    v_cmp_le_u32 vcc, 32, v4
    s_lshl_b32 s80, s80, 10
    s_add_u32 s80, s80, 327680
    v_lshlrev_b32 v5, 7, v0
    v_add_u32 v5, s80, v5
    s_mov_b32 s78, 0xff010101
    s_mov_b32 s79, -1
    s_or_b64 s[78:79], s[78:79], vcc
    s_mov_b64 vcc, s[78:79]
    v_mov_b32 v7, 2147418112
    v_cndmask_b32 v6, v5, v7, vcc
    s_mov_b32 s90, 0
L_gs_8:
    buffer_load_dwordx4 v[32:35], v6, s[16:19], 0 offen sc1
    s_add_u32 s90, s90, 1
    s_waitcnt vmcnt(0)
    v_cmp_eq_u64 vcc, s[66:67], v[32:33]
    s_or_b64 vcc, vcc, s[78:79]
    s_cmp_eq_u64 vcc, -1
    s_cbranch_scc1 L_gk_9
    s_cmp_lt_u32 s90, 20000
    s_cbranch_scc1 L_gs_8
L_gk_9:
    s_mov_b32 s82, 0xfe00
    v_cmp_eq_u32 vcc, s75, v34
    s_and_b32 s80, vcc_lo, s82
    s_cmp_eq_u32 s80, s82
    s_cselect_b32 s80, 1, 0
    v_mov_b32 v4, 159856
    v_mov_b32 v5, s80
    ds_write_b32 v4, v5
    s_mov_b64 exec, 1
    v_mov_b32 v4, 159824
    v_mov_b32 v5, 1
    ds_add_u32 v4, v5
    s_mov_b64 exec, -1
L_gw_10:
    v_mov_b32 v4, 159824
    s_mov_b32 s90, 0
L_ls_11:
    ds_read_b32 v5, v4
    s_add_u32 s90, s90, 1
    s_waitcnt lgkmcnt(0)
    v_readfirstlane_b32 s100, v5
    s_cmp_ge_u32 s100, 1
    s_cbranch_scc1 L_lk_12
    s_cmp_lt_u32 s90, 400000
    s_cbranch_scc1 L_ls_11
L_lk_12:
    v_mov_b32 v4, 159856
    ds_read_b32 v5, v4
    s_waitcnt lgkmcnt(0)
    v_readfirstlane_b32 s3, v5
    s_mul_i32 s85, s69, 458752
    s_add_u32 s85, s85, 1048576
    buffer_load_dwordx4 v[32:35], v29, s[16:19], s85 offen sc1
    buffer_load_dwordx4 v[36:39], v30, s[16:19], s85 offen sc1
    s_add_u32 s85, s85, 0x10000
    buffer_load_dwordx4 v[40:43], v29, s[16:19], s85 offen sc1
    buffer_load_dwordx4 v[44:47], v30, s[16:19], s85 offen sc1
    s_add_u32 s85, s85, 0x10000
    buffer_load_dwordx4 v[48:51], v29, s[16:19], s85 offen sc1
    buffer_load_dwordx4 v[52:55], v30, s[16:19], s85 offen sc1
    s_add_u32 s85, s85, 0x10000
    buffer_load_dwordx4 v[56:59], v29, s[16:19], s85 offen sc1
    buffer_load_dwordx4 v[60:63], v30, s[16:19], s85 offen sc1
    s_add_u32 s85, s85, 0x10000
    buffer_load_dwordx4 v[64:67], v29, s[16:19], s85 offen sc1
    buffer_load_dwordx4 v[68:71], v30, s[16:19], s85 offen sc1
    s_add_u32 s85, s85, 0x10000
    buffer_load_dwordx4 v[72:75], v29, s[16:19], s85 offen sc1
    buffer_load_dwordx4 v[76:79], v30, s[16:19], s85 offen sc1
    s_add_u32 s85, s85, 0x10000
    buffer_load_dwordx4 v[80:83], v29, s[16:19], s85 offen sc1
    buffer_load_dwordx4 v[84:87], v30, s[16:19], s85 offen sc1
    v_mov_b32 v4, 159760
    s_mov_b32 s90, 0
L_ls_13:
    ds_read_b32 v5, v4
    s_add_u32 s90, s90, 1
    s_waitcnt lgkmcnt(0)
    v_readfirstlane_b32 s100, v5
    s_cmp_ge_u32 s100, 4
    s_cbranch_scc1 L_lk_14
    s_cmp_lt_u32 s90, 400000
    s_cbranch_scc1 L_ls_13
L_lk_14:
    s_waitcnt vmcnt(12)
    v_mfma_f32_32x32x16_bf16 a[64:79], a[0:3], v[36:39], 0
    v_mfma_f32_32x32x16_bf16 a[80:95], a[4:7], v[32:35], 0
    v_mfma_f32_32x32x16_bf16 a[96:111], a[4:7], v[36:39], 0
    v_mfma_f32_32x32x16_bf16 v[104:119], a[0:3], v[32:35], v[104:119]
    s_waitcnt vmcnt(10)
    v_mfma_f32_32x32x16_bf16 a[64:79], a[8:11], v[44:47], a[64:79]
    v_mfma_f32_32x32x16_bf16 a[80:95], a[12:15], v[40:43], a[80:95]
    v_mfma_f32_32x32x16_bf16 a[96:111], a[12:15], v[44:47], a[96:111]
    v_mfma_f32_32x32x16_bf16 v[104:119], a[8:11], v[40:43], v[104:119]
    s_waitcnt vmcnt(8)
    v_mfma_f32_32x32x16_bf16 a[64:79], a[16:19], v[52:55], a[64:79]
    v_mfma_f32_32x32x16_bf16 a[80:95], a[20:23], v[48:51], a[80:95]
    v_mfma_f32_32x32x16_bf16 a[96:111], a[20:23], v[52:55], a[96:111]
    v_mfma_f32_32x32x16_bf16 v[104:119], a[16:19], v[48:51], v[104:119]
    s_waitcnt vmcnt(6)
    v_mfma_f32_32x32x16_bf16 a[64:79], a[24:27], v[60:63], a[64:79]
    v_mfma_f32_32x32x16_bf16 a[80:95], a[28:31], v[56:59], a[80:95]
    v_mfma_f32_32x32x16_bf16 a[96:111], a[28:31], v[60:63], a[96:111]
    v_mfma_f32_32x32x16_bf16 v[104:119], a[24:27], v[56:59], v[104:119]
    s_waitcnt vmcnt(4)
    v_mfma_f32_32x32x16_bf16 a[64:79], a[32:35], v[68:71], a[64:79]
    v_mfma_f32_32x32x16_bf16 a[80:95], a[36:39], v[64:67], a[80:95]
    v_mfma_f32_32x32x16_bf16 a[96:111], a[36:39], v[68:71], a[96:111]
    v_mfma_f32_32x32x16_bf16 v[104:119], a[32:35], v[64:67], v[104:119]
    s_waitcnt vmcnt(2)
    v_mfma_f32_32x32x16_bf16 a[64:79], a[40:43], v[76:79], a[64:79]
    v_mfma_f32_32x32x16_bf16 a[80:95], a[44:47], v[72:75], a[80:95]
    v_mfma_f32_32x32x16_bf16 a[96:111], a[44:47], v[76:79], a[96:111]
    v_mfma_f32_32x32x16_bf16 v[104:119], a[40:43], v[72:75], v[104:119]
    s_waitcnt vmcnt(0)
    v_mfma_f32_32x32x16_bf16 a[64:79], a[48:51], v[84:87], a[64:79]
    v_mfma_f32_32x32x16_bf16 a[80:95], a[52:55], v[80:83], a[80:95]
    v_mfma_f32_32x32x16_bf16 a[96:111], a[52:55], v[84:87], a[96:111]
    v_mfma_f32_32x32x16_bf16 v[104:119], a[48:51], v[80:83], v[104:119]
    s_add_u32 m0, s86, 6144
    s_add_u32 s80, s96, 172032
    buffer_load_dwordx4 v26, s[12:15], s80 offen lds
    s_add_u32 m0, s86, 7168
    s_add_u32 s80, s96, 200704
    buffer_load_dwordx4 v26, s[12:15], s80 offen lds
    s_nop 3
    ds_write_b128 v120, a[64:67] offset:0
    ds_write_b128 v120, a[68:71] offset:1024
    ds_write_b128 v120, a[72:75] offset:2048
    s_add_u32 s96, s96, 229376
    s_cmp_ge_u32 s96, 1605632
    s_cselect_b32 s80, 1605632, 0
    s_sub_u32 s96, s96, s80
    s_add_u32 m0, s86, 8192
    s_add_u32 s80, s96, 0
    buffer_load_dwordx4 v26, s[12:15], s80 offen lds
    s_add_u32 m0, s86, 9216
    s_add_u32 s80, s96, 28672
    buffer_load_dwordx4 v26, s[12:15], s80 offen lds
    ds_write_b128 v120, a[76:79] offset:3072
    ds_write_b128 v120, a[80:83] offset:4096
    s_add_u32 m0, s86, 10240
    s_add_u32 s80, s96, 57344
    buffer_load_dwordx4 v26, s[12:15], s80 offen lds
    s_add_u32 m0, s86, 11264
    s_add_u32 s80, s96, 86016
    buffer_load_dwordx4 v26, s[12:15], s80 offen lds
    ds_write_b128 v120, a[84:87] offset:5120
    ds_write_b128 v120, a[88:91] offset:6144
    ds_write_b128 v120, a[92:95] offset:7168
    s_add_u32 m0, s86, 12288
    s_add_u32 s80, s96, 114688
    buffer_load_dwordx4 v26, s[12:15], s80 offen lds
    s_add_u32 m0, s86, 13312
    s_add_u32 s80, s96, 143360
    buffer_load_dwordx4 v26, s[12:15], s80 offen lds
    ds_write_b128 v120, a[96:99] offset:8192
    ds_write_b128 v120, a[100:103] offset:9216
    s_add_u32 m0, s87, 0
    s_add_u32 s80, s96, 172032
    buffer_load_dwordx4 v26, s[12:15], s80 offen lds
    s_add_u32 m0, s87, 1024
    s_add_u32 s80, s96, 200704
    buffer_load_dwordx4 v26, s[12:15], s80 offen lds
    ds_write_b128 v120, a[104:107] offset:10240
    ds_write_b128 v120, a[108:111] offset:11264
    s_mov_b64 exec, 1
    v_mov_b32 v4, 159772
    v_mov_b32 v5, 1
    ds_add_u32 v4, v5
    s_mov_b64 exec, -1
    s_add_u32 s96, s96, 229376
    s_cmp_ge_u32 s96, 1605632
    s_cselect_b32 s80, 1605632, 0
    s_sub_u32 s96, s96, s80
    s_add_u32 m0, s87, 2048
    s_add_u32 s80, s96, 0
    buffer_load_dwordx4 v26, s[12:15], s80 offen lds
    s_add_u32 m0, s87, 3072
    s_add_u32 s80, s96, 28672
    buffer_load_dwordx4 v26, s[12:15], s80 offen lds
    v_mov_b32 v4, 159772
    s_mov_b32 s90, 0
L_ls_15:
    ds_read_b32 v5, v4
    s_add_u32 s90, s90, 1
    s_waitcnt lgkmcnt(0)
    v_readfirstlane_b32 s100, v5
    s_cmp_ge_u32 s100, 4
    s_cbranch_scc1 L_lk_16
    s_cmp_lt_u32 s90, 400000
    s_cbranch_scc1 L_ls_15
L_lk_16:
    ds_read_b128 v[32:35], v121 offset:0
    ds_read_b128 v[36:39], v121 offset:1024
    ds_read_b128 v[40:43], v121 offset:2048
    ds_read_b128 v[44:47], v121 offset:3072
    ds_read_b128 v[48:51], v122 offset:4096
    ds_read_b128 v[52:55], v122 offset:5120
    ds_read_b128 v[56:59], v122 offset:6144
    ds_read_b128 v[60:63], v122 offset:7168
    ds_read_b128 v[64:67], v123 offset:8192
    ds_read_b128 v[68:71], v123 offset:9216
    ds_read_b128 v[72:75], v123 offset:10240
    ds_read_b128 v[76:79], v123 offset:11264
    s_waitcnt lgkmcnt(8)
    v_add_f32 v104, v104, v32
    v_add_f32 v105, v105, v33
    v_add_f32 v106, v106, v34
    v_add_f32 v107, v107, v35
    v_add_f32 v108, v108, v36
    v_add_f32 v109, v109, v37
    v_add_f32 v110, v110, v38
    v_add_f32 v111, v111, v39
    v_add_f32 v112, v112, v40
    v_add_f32 v113, v113, v41
    v_add_f32 v114, v114, v42
    v_add_f32 v115, v115, v43
    v_add_f32 v116, v116, v44
    v_add_f32 v117, v117, v45
    v_add_f32 v118, v118, v46
    v_add_f32 v119, v119, v47
    s_waitcnt lgkmcnt(4)
    v_add_f32 v104, v104, v48
    v_add_f32 v105, v105, v49
    v_add_f32 v106, v106, v50
    v_add_f32 v107, v107, v51
    v_add_f32 v108, v108, v52
    v_add_f32 v109, v109, v53
    v_add_f32 v110, v110, v54
    v_add_f32 v111, v111, v55
    v_add_f32 v112, v112, v56
    v_add_f32 v113, v113, v57
    v_add_f32 v114, v114, v58
    v_add_f32 v115, v115, v59
    v_add_f32 v116, v116, v60
    v_add_f32 v117, v117, v61
    v_add_f32 v118, v118, v62
    v_add_f32 v119, v119, v63
    s_waitcnt lgkmcnt(0)
    v_add_f32 v104, v104, v64
    v_add_f32 v105, v105, v65
    v_add_f32 v106, v106, v66
    v_add_f32 v107, v107, v67
    v_add_f32 v108, v108, v68
    v_add_f32 v109, v109, v69
    v_add_f32 v110, v110, v70
    v_add_f32 v111, v111, v71
    v_add_f32 v112, v112, v72
    v_add_f32 v113, v113, v73
    v_add_f32 v114, v114, v74
    v_add_f32 v115, v115, v75
    v_add_f32 v116, v116, v76
    v_add_f32 v117, v117, v77
    v_add_f32 v118, v118, v78
    v_add_f32 v119, v119, v79
    v_cvt_pk_bf16_f32 v16, v104, v105
    v_cvt_pk_bf16_f32 v17, v106, v107
    v_cvt_pk_bf16_f32 v18, v108, v109
    v_cvt_pk_bf16_f32 v19, v110, v111
    v_cvt_pk_bf16_f32 v20, v112, v113
    v_cvt_pk_bf16_f32 v21, v114, v115
    v_cvt_pk_bf16_f32 v22, v116, v117
    v_cvt_pk_bf16_f32 v23, v118, v119
    s_mul_i32 s80, s74, 14
    s_add_u32 s80, s80, s84
    s_lshl_b32 s81, s80, 11
    s_add_u32 s81, s81, 3145728
    s_lshl_b32 s80, s80, 8
    s_add_u32 s82, s80, 2883584
    s_cmp_lg_u32 s3, 0
    s_cbranch_scc1 L_hn_17
    buffer_store_dwordx4 v[16:19], v1, s[16:19], s81 offen sc1
    buffer_store_dwordx4 v[20:23], v1, s[16:19], s81 offen offset:1024 sc1
    s_branch L_hd_18
L_hn_17:
    buffer_store_dwordx4 v[16:19], v1, s[16:19], s81 offen
    buffer_store_dwordx4 v[20:23], v1, s[16:19], s81 offen offset:1024
L_hd_18:
    v_add_f32 v32, v104, v105
    v_mul_f32 v33, v104, v104
    v_fma_f32 v33, v105, v105, v33
    v_add_f32 v32, v32, v106
    v_fma_f32 v33, v106, v106, v33
    v_add_f32 v32, v32, v107
    v_fma_f32 v33, v107, v107, v33
    v_add_f32 v32, v32, v108
    v_fma_f32 v33, v108, v108, v33
    v_add_f32 v32, v32, v109
    v_fma_f32 v33, v109, v109, v33
    v_add_f32 v32, v32, v110
    v_fma_f32 v33, v110, v110, v33
    v_add_f32 v32, v32, v111
    v_fma_f32 v33, v111, v111, v33
    v_add_f32 v32, v32, v112
    v_fma_f32 v33, v112, v112, v33
    v_add_f32 v32, v32, v113
    v_fma_f32 v33, v113, v113, v33
    v_add_f32 v32, v32, v114
    v_fma_f32 v33, v114, v114, v33
    v_add_f32 v32, v32, v115
    v_fma_f32 v33, v115, v115, v33
    v_add_f32 v32, v32, v116
    v_fma_f32 v33, v116, v116, v33
    v_add_f32 v32, v32, v117
    v_fma_f32 v33, v117, v117, v33
    v_add_f32 v32, v32, v118
    v_fma_f32 v33, v118, v118, v33
    v_add_f32 v32, v32, v119
    v_fma_f32 v33, v119, v119, v33
    v_mov_b32 v34, v32
    s_nop 1
    v_permlane32_swap_b32 v32, v34
    v_mov_b32 v35, v33
    s_nop 1
    v_permlane32_swap_b32 v33, v35
    v_add_f32 v32, v32, v34
    v_add_f32 v33, v33, v35
    v_lshlrev_b32 v34, 3, v0
    s_not_b64 exec, s[76:77]
    s_cmp_lg_u32 s3, 0
    s_cbranch_scc1 L_hn_19
    buffer_store_dwordx2 v[32:33], v34, s[16:19], s82 offen sc1
    s_branch L_hd_20
L_hn_19:
    buffer_store_dwordx2 v[32:33], v34, s[16:19], s82 offen
L_hd_20:
    s_mov_b64 exec, -1
    s_add_u32 m0, s87, 4096
    s_add_u32 s80, s96, 57344
    buffer_load_dwordx4 v26, s[12:15], s80 offen lds
    s_add_u32 m0, s87, 5120
    s_add_u32 s80, s96, 86016
    buffer_load_dwordx4 v26, s[12:15], s80 offen lds
    s_add_u32 m0, s87, 6144
    s_add_u32 s80, s96, 114688
    buffer_load_dwordx4 v26, s[12:15], s80 offen lds
    s_add_u32 m0, s87, 7168
    s_add_u32 s80, s96, 143360
    buffer_load_dwordx4 v26, s[12:15], s80 offen lds
    s_add_u32 m0, s87, 8192
    s_add_u32 s80, s96, 172032
    buffer_load_dwordx4 v26, s[12:15], s80 offen lds
    s_add_u32 m0, s87, 9216
    s_add_u32 s80, s96, 200704
    buffer_load_dwordx4 v26, s[12:15], s80 offen lds
    s_mul_i32 s91, s70, 224
    s_lshl_b32 s80, s71, 2
    s_add_u32 s80, s80, s69
    s_sub_u32 s80, s80, 4
    s_lshl_b32 s80, s80, 2
    s_add_u32 s91, s91, s80
    s_lshl_b32 s91, s91, 10
    s_add_u32 s91, s91, 5242880
    ds_read_b64_tr_b16 a[0:1], v2 offset:0
    ds_read_b64_tr_b16 a[2:3], v2 offset:1024
    ds_read_b64_tr_b16 a[4:5], v3 offset:0
    ds_read_b64_tr_b16 a[6:7], v3 offset:1024
    ds_read_b64_tr_b16 a[8:9], v2 offset:2048
    ds_read_b64_tr_b16 a[10:11], v2 offset:3072
    ds_read_b64_tr_b16 a[12:13], v3 offset:2048
    ds_read_b64_tr_b16 a[14:15], v3 offset:3072
    s_waitcnt lgkmcnt(4)
    s_add_u32 s96, s96, 229376
    s_cmp_ge_u32 s96, 1605632
    s_cselect_b32 s80, 1605632, 0
    s_sub_u32 s96, s96, s80
    s_add_u32 m0, s86, 0
    s_add_u32 s80, s96, 0
    buffer_load_dwordx4 v26, s[12:15], s80 offen lds
    s_add_u32 m0, s86, 1024
    s_add_u32 s80, s96, 28672
    buffer_load_dwordx4 v26, s[12:15], s80 offen lds
    ds_read_b64_tr_b16 a[16:17], v2 offset:4096
    ds_read_b64_tr_b16 a[18:19], v2 offset:5120
    ds_read_b64_tr_b16 a[20:21], v3 offset:4096
    ds_read_b64_tr_b16 a[22:23], v3 offset:5120
    s_waitcnt lgkmcnt(4)
    s_add_u32 m0, s86, 2048
    s_add_u32 s80, s96, 57344
    buffer_load_dwordx4 v26, s[12:15], s80 offen lds
    s_add_u32 m0, s86, 3072
    s_add_u32 s80, s96, 86016
    buffer_load_dwordx4 v26, s[12:15], s80 offen lds
    s_waitcnt vmcnt(23)
    ds_read_b64_tr_b16 a[24:25], v2 offset:6144
    ds_read_b64_tr_b16 a[26:27], v2 offset:7168
    ds_read_b64_tr_b16 a[28:29], v3 offset:6144
    ds_read_b64_tr_b16 a[30:31], v3 offset:7168
    s_waitcnt lgkmcnt(4)
    s_add_u32 m0, s86, 4096
    s_add_u32 s80, s96, 114688
    buffer_load_dwordx4 v26, s[12:15], s80 offen lds
    s_add_u32 m0, s86, 5120
    s_add_u32 s80, s96, 143360
    buffer_load_dwordx4 v26, s[12:15], s80 offen lds
    s_waitcnt vmcnt(23)
    ds_read_b64_tr_b16 a[32:33], v2 offset:8192
    ds_read_b64_tr_b16 a[34:35], v2 offset:9216
    ds_read_b64_tr_b16 a[36:37], v3 offset:8192
    ds_read_b64_tr_b16 a[38:39], v3 offset:9216
    s_waitcnt vmcnt(12)
    s_mov_b64 exec, 1
    v_mov_b32 v4, 159800
    v_mov_b32 v5, 1
    ds_add_rtn_u32 v5, v4, v5
    s_lshl_b32 s80, s70, 3
    s_add_u32 s80, s80, s71
    s_lshl_b32 s80, s80, 7
    s_add_u32 s80, s80, 360448
    s_waitcnt lgkmcnt(0)
    v_readfirstlane_b32 s81, v5
    s_cmp_lg_u32 s81, 3
    s_cbranch_scc1 L_sg_21
    s_mov_b64 exec, 255
    v_mov_b32 v4, s66
    v_mov_b32 v5, s67
    v_mov_b32 v6, s75
    s_cmp_lg_u32 s3, 0
    s_cbranch_scc1 L_hn_22
    buffer_store_dwordx4 v[4:7], v1, s[16:19], s80 offen sc1
    s_branch L_hd_23
L_hn_22:
    buffer_store_dwordx4 v[4:7], v1, s[16:19], s80 offen
L_hd_23:
L_sg_21:
    s_mov_b64 exec, -1
    s_nop 0
    s_add_u32 m0, s86, 6144
    s_add_u32 s80, s96, 172032
    buffer_load_dwordx4 v26, s[12:15], s80 offen lds
    s_add_u32 m0, s86, 7168
    s_add_u32 s80, s96, 200704
    buffer_load_dwordx4 v26, s[12:15], s80 offen lds
    ds_read_b64_tr_b16 a[40:41], v2 offset:10240
    ds_read_b64_tr_b16 a[42:43], v2 offset:11264
    ds_read_b64_tr_b16 a[44:45], v3 offset:10240
    ds_read_b64_tr_b16 a[46:47], v3 offset:11264
    s_add_u32 s96, s96, 229376
    s_cmp_ge_u32 s96, 1605632
    s_cselect_b32 s80, 1605632, 0
    s_sub_u32 s96, s96, s80
    s_add_u32 m0, s86, 8192
    s_add_u32 s80, s96, 0
    buffer_load_dwordx4 v26, s[12:15], s80 offen lds
    s_add_u32 m0, s86, 9216
    s_add_u32 s80, s96, 28672
    buffer_load_dwordx4 v26, s[12:15], s80 offen lds
    ds_read_b64_tr_b16 a[48:49], v2 offset:12288
    ds_read_b64_tr_b16 a[50:51], v2 offset:13312
    ds_read_b64_tr_b16 a[52:53], v3 offset:12288
    ds_read_b64_tr_b16 a[54:55], v3 offset:13312
    s_waitcnt lgkmcnt(4)
    s_add_u32 m0, s86, 10240
    s_add_u32 s80, s96, 57344
    buffer_load_dwordx4 v26, s[12:15], s80 offen lds
    s_add_u32 m0, s86, 11264
    s_add_u32 s80, s96, 86016
    buffer_load_dwordx4 v26, s[12:15], s80 offen lds
    ds_read_b64_tr_b16 a[56:57], v25 offset:0
    ds_read_b64_tr_b16 a[58:59], v25 offset:1024
    ds_read_b64_tr_b16 a[60:61], v31 offset:0
    ds_read_b64_tr_b16 a[62:63], v31 offset:1024
    s_waitcnt lgkmcnt(4)
    s_add_u32 m0, s86, 12288
    s_add_u32 s80, s96, 114688
    buffer_load_dwordx4 v26, s[12:15], s80 offen lds
    s_add_u32 m0, s86, 13312
    s_add_u32 s80, s96, 143360
    buffer_load_dwordx4 v26, s[12:15], s80 offen lds
    ds_read_b64_tr_b16 a[64:65], v25 offset:2048
    ds_read_b64_tr_b16 a[66:67], v25 offset:3072
    ds_read_b64_tr_b16 a[68:69], v31 offset:2048
    ds_read_b64_tr_b16 a[70:71], v31 offset:3072
    s_waitcnt lgkmcnt(4)
    s_add_u32 m0, s87, 0
    s_add_u32 s80, s96, 172032
    buffer_load_dwordx4 v26, s[12:15], s80 offen lds
    s_add_u32 m0, s87, 1024
    s_add_u32 s80, s96, 200704
    buffer_load_dwordx4 v26, s[12:15], s80 offen lds
    s_waitcnt lgkmcnt(0)
    s_add_u32 s96, s96, 229376
    s_cmp_ge_u32 s96, 1605632
    s_cselect_b32 s80, 1605632, 0
    s_sub_u32 s96, s96, s80
    s_add_u32 m0, s87, 2048
    s_add_u32 s80, s96, 0
    buffer_load_dwordx4 v26, s[12:15], s80 offen lds
    s_add_u32 m0, s87, 3072
    s_add_u32 s80, s96, 28672
    buffer_load_dwordx4 v26, s[12:15], s80 offen lds
    s_cmp_lg_u32 s69, 0
    s_cbranch_scc1 L_gw_26
    s_lshl_b32 s80, s70, 10
    s_add_u32 s80, s80, 360448
    s_lshl_b32 s81, s71, 9
    s_add_u32 s81, s81, 297472
    v_lshlrev_b32 v4, 7, v0
    v_add_u32 v5, s80, v4
    v_add_u32 v4, s81, v4
    s_mov_b64 vcc, 0xff
    v_cndmask_b32 v5, v4, v5, vcc
    s_mov_b32 s78, 0xfffff001
    s_mov_b32 s79, -1
    s_mov_b64 vcc, s[78:79]
    v_mov_b32 v7, 2147418112
    v_cndmask_b32 v6, v5, v7, vcc
    s_mov_b32 s90, 0
L_gs_24:
    buffer_load_dwordx2 v[32:33], v6, s[16:19], 0 offen sc1
    s_add_u32 s90, s90, 1
    s_waitcnt vmcnt(0)
    v_cmp_eq_u64 vcc, s[66:67], v[32:33]
    s_or_b64 vcc, vcc, s[78:79]
    s_cmp_eq_u64 vcc, -1
    s_cbranch_scc1 L_gk_25
    s_cmp_lt_u32 s90, 20000
    s_cbranch_scc1 L_gs_24
L_gk_25:
    s_mov_b64 exec, 1
    v_mov_b32 v4, 159828
    v_mov_b32 v5, 1
    ds_add_u32 v4, v5
    s_mov_b64 exec, -1
L_gw_26:
    v_mov_b32 v4, 159828
    s_mov_b32 s90, 0
L_ls_27:
    ds_read_b32 v5, v4
    s_add_u32 s90, s90, 1
    s_waitcnt lgkmcnt(0)
    v_readfirstlane_b32 s100, v5
    s_cmp_ge_u32 s100, 1
    s_cbranch_scc1 L_lk_28
    s_cmp_lt_u32 s90, 400000
    s_cbranch_scc1 L_ls_27
L_lk_28:
    s_mul_i32 s81, s70, 57344
    s_add_u32 s81, s81, 3145728
    s_lshl_b32 s83, s69, 10
    s_lshl_b32 s82, s93, 12
    s_add_u32 s82, s82, s83
    s_add_u32 s83, s83, 57344
    s_add_u32 s85, s81, s82
    s_add_u32 m0, s83, 0
    s_add_u32 s80, s85, 0
    buffer_load_dwordx4 v1, s[16:19], s80 offen sc1 lds
    s_add_u32 m0, s83, 28672
    s_add_u32 s80, s85, 28672
    buffer_load_dwordx4 v1, s[16:19], s80 offen sc1 lds
    s_add_u32 s82, s82, 4096
    s_sub_u32 s85, s82, 28672
    s_cmp_ge_u32 s82, 28672
    s_cselect_b32 s82, s85, s82
    s_add_u32 s85, s81, s82
    s_add_u32 m0, s83, 4096
    s_add_u32 s80, s85, 0
    buffer_load_dwordx4 v1, s[16:19], s80 offen sc1 lds
    s_add_u32 m0, s83, 32768
    s_add_u32 s80, s85, 28672
    buffer_load_dwordx4 v1, s[16:19], s80 offen sc1 lds
    s_add_u32 s82, s82, 4096
    s_sub_u32 s85, s82, 28672
    s_cmp_ge_u32 s82, 28672
    s_cselect_b32 s82, s85, s82
    s_add_u32 s85, s81, s82
    s_add_u32 m0, s83, 8192
    s_add_u32 s80, s85, 0
    buffer_load_dwordx4 v1, s[16:19], s80 offen sc1 lds
    s_add_u32 m0, s83, 36864
    s_add_u32 s80, s85, 28672
    buffer_load_dwordx4 v1, s[16:19], s80 offen sc1 lds
    s_add_u32 s82, s82, 4096
    s_sub_u32 s85, s82, 28672
    s_cmp_ge_u32 s82, 28672
    s_cselect_b32 s82, s85, s82
    s_add_u32 s85, s81, s82
    s_add_u32 m0, s83, 12288
    s_add_u32 s80, s85, 0
    buffer_load_dwordx4 v1, s[16:19], s80 offen sc1 lds
    s_add_u32 m0, s83, 40960
    s_add_u32 s80, s85, 28672
    buffer_load_dwordx4 v1, s[16:19], s80 offen sc1 lds
    s_add_u32 s82, s82, 4096
    s_sub_u32 s85, s82, 28672
    s_cmp_ge_u32 s82, 28672
    s_cselect_b32 s82, s85, s82
    s_add_u32 s85, s81, s82
    s_add_u32 m0, s83, 16384
    s_add_u32 s80, s85, 0
    buffer_load_dwordx4 v1, s[16:19], s80 offen sc1 lds
    s_add_u32 m0, s83, 45056
    s_add_u32 s80, s85, 28672
    buffer_load_dwordx4 v1, s[16:19], s80 offen sc1 lds
    s_add_u32 s82, s82, 4096
    s_sub_u32 s85, s82, 28672
    s_cmp_ge_u32 s82, 28672
    s_cselect_b32 s82, s85, s82
    s_add_u32 s85, s81, s82
    s_add_u32 m0, s83, 20480
    s_add_u32 s80, s85, 0
    buffer_load_dwordx4 v1, s[16:19], s80 offen sc1 lds
    s_add_u32 m0, s83, 49152
    s_add_u32 s80, s85, 28672
    buffer_load_dwordx4 v1, s[16:19], s80 offen sc1 lds
    s_add_u32 s82, s82, 4096
    s_sub_u32 s85, s82, 28672
    s_cmp_ge_u32 s82, 28672
    s_cselect_b32 s82, s85, s82
    s_add_u32 s85, s81, s82
    s_add_u32 m0, s83, 24576
    s_add_u32 s80, s85, 0
    buffer_load_dwordx4 v1, s[16:19], s80 offen sc1 lds
    s_add_u32 m0, s83, 53248
    s_add_u32 s80, s85, 28672
    buffer_load_dwordx4 v1, s[16:19], s80 offen sc1 lds
    v_and_b32 v4, 31, v0
    v_lshrrev_b32 v5, 5, v0
    v_mul_u32_u24 v5, 3584, v5
    v_lshl_add_u32 v6, v4, 3, v5
    s_mul_i32 s81, s70, 7168
    s_lshl_b32 s82, s69, 8
    s_add_u32 s81, s81, s82
    s_add_u32 s81, s81, 2883584
    s_cmp_lt_u32 s69, 2
    s_cselect_b32 s82, s81, 2147418112
    v_add_u32 v27, 57344, v1
    buffer_load_dwordx2 v[32:33], v6, s[16:19], s81 offen offset:0 sc1
    buffer_load_dwordx2 v[34:35], v6, s[16:19], s81 offen offset:1024 sc1
    buffer_load_dwordx2 v[36:37], v6, s[16:19], s81 offen offset:2048 sc1
    buffer_load_dwordx2 v[38:39], v6, s[16:19], s82 offen offset:3072 sc1
    s_lshl_b32 s81, s71, 2
    s_add_u32 s81, s81, s69
    s_lshl_b32 s81, s81, 9
    s_add_u32 s81, s81, 260096
    v_lshlrev_b32 v7, 3, v0
    buffer_load_dwordx2 v[28:29], v7, s[16:19], s81 offen sc1
    s_waitcnt vmcnt(15)
    s_mov_b64 exec, 1
    v_mov_b32 v4, 159776
    v_mov_b32 v5, 1
    ds_add_u32 v4, v5
    s_mov_b64 exec, -1
    v_mov_b32 v4, 159776
    s_mov_b32 s90, 0
L_ls_29:
    ds_read_b32 v5, v4
    s_add_u32 s90, s90, 1
    s_waitcnt lgkmcnt(0)
    v_readfirstlane_b32 s100, v5
    s_cmp_ge_u32 s100, 4
    s_cbranch_scc1 L_lk_30
    s_cmp_lt_u32 s90, 400000
    s_cbranch_scc1 L_ls_29
L_lk_30:
    ds_read_b128 v[40:43], v27 offset:0
    ds_read_b128 v[44:47], v27 offset:28672
    ds_read_b128 v[48:51], v27 offset:1024
    ds_read_b128 v[52:55], v27 offset:29696
    s_waitcnt lgkmcnt(2)
    v_mfma_f32_32x32x16_bf16 v[64:79], a[0:3], v[40:43], 0
    ds_read_b128 v[56:59], v27 offset:2048
    ds_read_b128 v[60:63], v27 offset:30720
    ds_read_b64_tr_b16 a[72:73], v25 offset:4096
    ds_read_b64_tr_b16 a[74:75], v25 offset:5120
    v_mfma_f32_32x32x16_bf16 v[80:95], a[0:3], v[44:47], 0
    ds_read_b64_tr_b16 a[76:77], v31 offset:4096
    ds_read_b64_tr_b16 a[78:79], v31 offset:5120
    v_mfma_f32_32x32x16_bf16 v[96:111], a[4:7], v[40:43], 0
    ds_read_b64_tr_b16 a[80:81], v25 offset:6144
    ds_read_b64_tr_b16 a[82:83], v25 offset:7168
    v_mfma_f32_32x32x16_bf16 v[112:127], a[4:7], v[44:47], 0
    ds_read_b64_tr_b16 a[84:85], v31 offset:6144
    ds_read_b64_tr_b16 a[86:87], v31 offset:7168
    s_waitcnt lgkmcnt(10)
    v_mfma_f32_32x32x16_bf16 v[64:79], a[8:11], v[48:51], v[64:79]
    ds_read_b128 v[40:43], v27 offset:3072
    ds_read_b128 v[44:47], v27 offset:31744
    s_waitcnt lgkmcnt(6)
    s_add_u32 m0, s87, 4096
    s_add_u32 s80, s96, 57344
    buffer_load_dwordx4 v26, s[12:15], s80 offen lds
    ds_read_b64_tr_b16 a[88:89], v25 offset:8192
    ds_read_b64_tr_b16 a[90:91], v25 offset:9216
    v_mfma_f32_32x32x16_bf16 v[80:95], a[8:11], v[52:55], v[80:95]
    s_add_u32 m0, s87, 5120
    s_add_u32 s80, s96, 86016
    buffer_load_dwordx4 v26, s[12:15], s80 offen lds
    ds_read_b64_tr_b16 a[92:93], v31 offset:8192
    ds_read_b64_tr_b16 a[94:95], v31 offset:9216
    v_mfma_f32_32x32x16_bf16 v[96:111], a[12:15], v[48:51], v[96:111]
    s_waitcnt lgkmcnt(6)
    s_add_u32 m0, s87, 6144
    s_add_u32 s80, s96, 114688
    buffer_load_dwordx4 v26, s[12:15], s80 offen lds
    ds_read_b64_tr_b16 a[96:97], v2 offset:0
    ds_read_b64_tr_b16 a[98:99], v2 offset:1024
    v_mfma_f32_32x32x16_bf16 v[112:127], a[12:15], v[52:55], v[112:127]
    s_add_u32 m0, s87, 7168
    s_add_u32 s80, s96, 143360
    buffer_load_dwordx4 v26, s[12:15], s80 offen lds
    ds_read_b64_tr_b16 a[100:101], v3 offset:0
    ds_read_b64_tr_b16 a[102:103], v3 offset:1024
    s_waitcnt vmcnt(15)
    s_mov_b64 exec, 1
    v_mov_b32 v4, 159776
    v_mov_b32 v5, 1
    ds_add_u32 v4, v5
    s_mov_b64 exec, -1
    v_mfma_f32_32x32x16_bf16 v[64:79], a[16:19], v[56:59], v[64:79]
    ds_read_b128 v[48:51], v27 offset:4096
    ds_read_b128 v[52:55], v27 offset:32768
    s_waitcnt lgkmcnt(7)
    s_add_u32 m0, s87, 8192
    s_add_u32 s80, s96, 172032
    buffer_load_dwordx4 v26, s[12:15], s80 offen lds
    ds_read_b64_tr_b16 a[104:105], v2 offset:2048
    ds_read_b64_tr_b16 a[106:107], v2 offset:3072
    v_mfma_f32_32x32x16_bf16 v[80:95], a[16:19], v[60:63], v[80:95]
    s_add_u32 m0, s87, 9216
    s_add_u32 s80, s96, 200704
    buffer_load_dwordx4 v26, s[12:15], s80 offen lds
    ds_read_b64_tr_b16 a[108:109], v3 offset:2048
    ds_read_b64_tr_b16 a[110:111], v3 offset:3072
    v_mfma_f32_32x32x16_bf16 v[96:111], a[20:23], v[56:59], v[96:111]
    s_waitcnt lgkmcnt(7)
    s_add_u32 s96, s96, 229376
    s_cmp_ge_u32 s96, 1605632
    s_cselect_b32 s80, 1605632, 0
    s_sub_u32 s96, s96, s80
    s_add_u32 m0, s86, 0
    s_add_u32 s80, s96, 0
    buffer_load_dwordx4 v26, s[12:15], s80 offen lds
    ds_read_b64_tr_b16 a[112:113], v2 offset:4096
    ds_read_b64_tr_b16 a[114:115], v2 offset:5120
    v_mfma_f32_32x32x16_bf16 v[112:127], a[20:23], v[60:63], v[112:127]
    s_add_u32 m0, s86, 1024
    s_add_u32 s80, s96, 28672
    buffer_load_dwordx4 v26, s[12:15], s80 offen lds
    ds_read_b64_tr_b16 a[116:117], v3 offset:4096
    ds_read_b64_tr_b16 a[118:119], v3 offset:5120
    v_mfma_f32_32x32x16_bf16 v[64:79], a[24:27], v[40:43], v[64:79]
    ds_read_b128 v[56:59], v27 offset:5120
    ds_read_b128 v[60:63], v27 offset:33792
    s_waitcnt lgkmcnt(6)
    s_add_u32 m0, s86, 2048
    s_add_u32 s80, s96, 57344
    buffer_load_dwordx4 v26, s[12:15], s80 offen lds
    ds_read_b64_tr_b16 a[120:121], v2 offset:6144
    ds_read_b64_tr_b16 a[122:123], v2 offset:7168
    v_mfma_f32_32x32x16_bf16 v[80:95], a[24:27], v[44:47], v[80:95]
    s_add_u32 m0, s86, 3072
    s_add_u32 s80, s96, 86016
    buffer_load_dwordx4 v26, s[12:15], s80 offen lds
    ds_read_b64_tr_b16 a[124:125], v3 offset:6144
    ds_read_b64_tr_b16 a[126:127], v3 offset:7168
    v_mfma_f32_32x32x16_bf16 v[96:111], a[28:31], v[40:43], v[96:111]
    s_waitcnt lgkmcnt(6)
    s_add_u32 m0, s86, 4096
    s_add_u32 s80, s96, 114688
    buffer_load_dwordx4 v26, s[12:15], s80 offen lds
    ds_read_b64_tr_b16 a[0:1], v2 offset:8192
    ds_read_b64_tr_b16 a[2:3], v2 offset:9216
    v_mfma_f32_32x32x16_bf16 v[112:127], a[28:31], v[44:47], v[112:127]
    s_add_u32 m0, s86, 5120
    s_add_u32 s80, s96, 143360
    buffer_load_dwordx4 v26, s[12:15], s80 offen lds
    ds_read_b64_tr_b16 a[4:5], v3 offset:8192
    ds_read_b64_tr_b16 a[6:7], v3 offset:9216
    v_mfma_f32_32x32x16_bf16 v[64:79], a[32:35], v[48:51], v[64:79]
    ds_read_b128 v[40:43], v27 offset:6144
    ds_read_b128 v[44:47], v27 offset:34816
    s_waitcnt lgkmcnt(6)
    s_add_u32 m0, s86, 6144
    s_add_u32 s80, s96, 172032
    buffer_load_dwordx4 v26, s[12:15], s80 offen lds
    ds_read_b64_tr_b16 a[8:9], v2 offset:10240
    ds_read_b64_tr_b16 a[10:11], v2 offset:11264
    v_mfma_f32_32x32x16_bf16 v[80:95], a[32:35], v[52:55], v[80:95]
    s_add_u32 m0, s86, 7168
    s_add_u32 s80, s96, 200704
    buffer_load_dwordx4 v26, s[12:15], s80 offen lds
    ds_read_b64_tr_b16 a[12:13], v3 offset:10240
    ds_read_b64_tr_b16 a[14:15], v3 offset:11264
    v_mfma_f32_32x32x16_bf16 v[96:111], a[36:39], v[48:51], v[96:111]
    s_waitcnt lgkmcnt(6)
    s_mul_i32 s96, s93, 57344
    s_add_u32 s83, s96, s89
    s_add_u32 m0, s86, 8192
    s_add_u32 s80, s83, 0
    buffer_load_dwordx4 v24, s[20:23], s80 offen lds
    ds_read_b64_tr_b16 a[16:17], v2 offset:12288
    ds_read_b64_tr_b16 a[18:19], v2 offset:13312
    v_mfma_f32_32x32x16_bf16 v[112:127], a[36:39], v[52:55], v[112:127]
    s_add_u32 m0, s86, 9216
    s_add_u32 s80, s83, 7168
    buffer_load_dwordx4 v24, s[20:23], s80 offen lds
    ds_read_b64_tr_b16 a[20:21], v3 offset:12288
    ds_read_b64_tr_b16 a[22:23], v3 offset:13312
    v_mov_b32 v4, 159776
    s_mov_b32 s90, 0
L_ls_31:
    ds_read_b32 v5, v4
    s_add_u32 s90, s90, 1
    s_waitcnt lgkmcnt(0)
    v_readfirstlane_b32 s100, v5
    s_cmp_ge_u32 s100, 8
    s_cbranch_scc1 L_lk_32
    s_cmp_lt_u32 s90, 400000
    s_cbranch_scc1 L_ls_31
L_lk_32:
    v_mfma_f32_32x32x16_bf16 v[64:79], a[40:43], v[56:59], v[64:79]
    ds_read_b128 v[48:51], v27 offset:7168
    ds_read_b128 v[52:55], v27 offset:35840
    s_add_u32 m0, s86, 10240
    s_add_u32 s80, s83, 14336
    buffer_load_dwordx4 v24, s[20:23], s80 offen lds
    ds_read_b64_tr_b16 a[24:25], v25 offset:0
    ds_read_b64_tr_b16 a[26:27], v25 offset:1024
    v_mfma_f32_32x32x16_bf16 v[80:95], a[40:43], v[60:63], v[80:95]
    s_add_u32 m0, s86, 11264
    s_add_u32 s80, s83, 21504
    buffer_load_dwordx4 v24, s[20:23], s80 offen lds
    ds_read_b64_tr_b16 a[28:29], v31 offset:0
    ds_read_b64_tr_b16 a[30:31], v31 offset:1024
    v_mfma_f32_32x32x16_bf16 v[96:111], a[44:47], v[56:59], v[96:111]
    s_add_u32 s96, s96, 57344
    s_cmp_ge_u32 s96, 401408
    s_cselect_b32 s80, 401408, 0
    s_sub_u32 s96, s96, s80
    s_add_u32 s83, s96, s89
    s_add_u32 m0, s86, 12288
    s_add_u32 s80, s83, 0
    buffer_load_dwordx4 v24, s[20:23], s80 offen lds
    ds_read_b64_tr_b16 a[32:33], v25 offset:2048
    ds_read_b64_tr_b16 a[34:35], v25 offset:3072
    v_mfma_f32_32x32x16_bf16 v[112:127], a[44:47], v[60:63], v[112:127]
    s_add_u32 m0, s86, 13312
    s_add_u32 s80, s83, 7168
    buffer_load_dwordx4 v24, s[20:23], s80 offen lds
    ds_read_b64_tr_b16 a[36:37], v31 offset:2048
    ds_read_b64_tr_b16 a[38:39], v31 offset:3072
    v_mfma_f32_32x32x16_bf16 v[64:79], a[48:51], v[40:43], v[64:79]
    ds_read_b128 v[56:59], v27 offset:8192
    ds_read_b128 v[60:63], v27 offset:36864
    s_waitcnt lgkmcnt(6)
    s_add_u32 m0, s87, 0
    s_add_u32 s80, s83, 14336
    buffer_load_dwordx4 v24, s[20:23], s80 offen lds
    v_mfma_f32_32x32x16_bf16 v[80:95], a[48:51], v[44:47], v[80:95]
    s_add_u32 m0, s87, 1024
    s_add_u32 s80, s83, 21504
    buffer_load_dwordx4 v24, s[20:23], s80 offen lds
    v_mfma_f32_32x32x16_bf16 v[96:111], a[52:55], v[40:43], v[96:111]
    s_waitcnt lgkmcnt(2)
    s_add_u32 s96, s96, 57344
    s_cmp_ge_u32 s96, 401408
    s_cselect_b32 s80, 401408, 0
    s_sub_u32 s96, s96, s80
    s_add_u32 s83, s96, s89
    s_add_u32 m0, s87, 2048
    s_add_u32 s80, s83, 0
    buffer_load_dwordx4 v24, s[20:23], s80 offen lds
    v_mfma_f32_32x32x16_bf16 v[112:127], a[52:55], v[44:47], v[112:127]
    s_add_u32 m0, s87, 3072
    s_add_u32 s80, s83, 7168
    buffer_load_dwordx4 v24, s[20:23], s80 offen lds
    v_mfma_f32_32x32x16_bf16 v[64:79], a[56:59], v[48:51], v[64:79]
    ds_read_b128 v[40:43], v27 offset:9216
    ds_read_b128 v[44:47], v27 offset:37888
    v_mfma_f32_32x32x16_bf16 v[80:95], a[56:59], v[52:55], v[80:95]
    v_mfma_f32_32x32x16_bf16 v[96:111], a[60:63], v[48:51], v[96:111]
    v_mfma_f32_32x32x16_bf16 v[112:127], a[60:63], v[52:55], v[112:127]
    s_waitcnt vmcnt(24)
    v_add_f32 v32, v32, v34
    v_add_f32 v33, v33, v35
    v_add_f32 v36, v36, v38
    v_add_f32 v37, v37, v39
    s_lshl_b32 s80, s69, 9
    s_add_u32 s80, s80, 161792
    v_add_f32 v32, v32, v36
    v_add_f32 v33, v33, v37
    v_lshl_add_u32 v6, v0, 3, s80
    ds_write_b64 v6, v[32:33]
    s_mov_b64 exec, 1
    v_mov_b32 v4, 159780
    v_mov_b32 v5, 1
    ds_add_u32 v4, v5
    s_mov_b64 exec, -1
    s_waitcnt lgkmcnt(4)
    v_mfma_f32_32x32x16_bf16 v[64:79], a[64:67], v[56:59], v[64:79]
    ds_read_b128 v[48:51], v27 offset:10240
    ds_read_b128 v[52:55], v27 offset:38912
    s_waitcnt vmcnt(22)
    ds_read_b64_tr_b16 a[40:41], v25 offset:4096
    ds_read_b64_tr_b16 a[42:43], v25 offset:5120
    v_mfma_f32_32x32x16_bf16 v[80:95], a[64:67], v[60:63], v[80:95]
    ds_read_b64_tr_b16 a[44:45], v31 offset:4096
    ds_read_b64_tr_b16 a[46:47], v31 offset:5120
    v_mfma_f32_32x32x16_bf16 v[96:111], a[68:71], v[56:59], v[96:111]
    s_waitcnt vmcnt(20)
    ds_read_b64_tr_b16 a[48:49], v25 offset:6144
    ds_read_b64_tr_b16 a[50:51], v25 offset:7168
    v_mfma_f32_32x32x16_bf16 v[112:127], a[68:71], v[60:63], v[112:127]
    ds_read_b64_tr_b16 a[52:53], v31 offset:6144
    ds_read_b64_tr_b16 a[54:55], v31 offset:7168
    s_waitcnt lgkmcnt(12)
    v_mfma_f32_32x32x16_bf16 v[64:79], a[72:75], v[40:43], v[64:79]
    ds_read_b128 v[56:59], v27 offset:11264
    ds_read_b128 v[60:63], v27 offset:39936
    s_waitcnt lgkmcnt(6)
    s_add_u32 m0, s87, 4096
    s_add_u32 s80, s83, 14336
    buffer_load_dwordx4 v24, s[20:23], s80 offen lds
    s_waitcnt vmcnt(19)
    ds_read_b64_tr_b16 a[56:57], v25 offset:8192
    ds_read_b64_tr_b16 a[58:59], v25 offset:9216
    v_mfma_f32_32x32x16_bf16 v[80:95], a[72:75], v[44:47], v[80:95]
    s_add_u32 m0, s87, 5120
    s_add_u32 s80, s83, 21504
    buffer_load_dwordx4 v24, s[20:23], s80 offen lds
    ds_read_b64_tr_b16 a[60:61], v31 offset:8192
    ds_read_b64_tr_b16 a[62:63], v31 offset:9216
    v_mfma_f32_32x32x16_bf16 v[96:111], a[76:79], v[40:43], v[96:111]
    s_waitcnt lgkmcnt(6)
    s_add_u32 s96, s96, 57344
    s_cmp_ge_u32 s96, 401408
    s_cselect_b32 s80, 401408, 0
    s_sub_u32 s96, s96, s80
    s_add_u32 s83, s96, s89
    s_add_u32 m0, s87, 6144
    s_add_u32 s80, s83, 0
    buffer_load_dwordx4 v24, s[20:23], s80 offen lds
    s_waitcnt vmcnt(19)
    ds_read_b64_tr_b16 a[64:65], v2 offset:0
    ds_read_b64_tr_b16 a[66:67], v2 offset:1024
    v_mfma_f32_32x32x16_bf16 v[112:127], a[76:79], v[44:47], v[112:127]
    s_add_u32 m0, s87, 7168
    s_add_u32 s80, s83, 7168
    buffer_load_dwordx4 v24, s[20:23], s80 offen lds
    ds_read_b64_tr_b16 a[68:69], v3 offset:0
    ds_read_b64_tr_b16 a[70:71], v3 offset:1024
    v_mfma_f32_32x32x16_bf16 v[64:79], a[80:83], v[48:51], v[64:79]
    ds_read_b128 v[40:43], v27 offset:12288
    ds_read_b128 v[44:47], v27 offset:40960
    s_waitcnt lgkmcnt(6)
    s_add_u32 m0, s87, 8192
    s_add_u32 s80, s83, 14336
    buffer_load_dwordx4 v24, s[20:23], s80 offen lds
    v_mfma_f32_32x32x16_bf16 v[80:95], a[80:83], v[52:55], v[80:95]
    s_waitcnt vmcnt(19)
    ds_read_b64_tr_b16 a[72:73], v2 offset:2048
    ds_read_b64_tr_b16 a[74:75], v2 offset:3072
    s_add_u32 m0, s87, 9216
    s_add_u32 s80, s83, 21504
    buffer_load_dwordx4 v24, s[20:23], s80 offen lds
    v_mfma_f32_32x32x16_bf16 v[96:111], a[84:87], v[48:51], v[96:111]
    ds_read_b64_tr_b16 a[76:77], v3 offset:2048
    ds_read_b64_tr_b16 a[78:79], v3 offset:3072
    s_waitcnt lgkmcnt(6)
    s_add_u32 s96, s96, 57344
    s_cmp_ge_u32 s96, 401408
    s_cselect_b32 s80, 401408, 0
    s_sub_u32 s96, s96, s80
    s_add_u32 s83, s96, s89
    s_add_u32 m0, s86, 0
    s_add_u32 s80, s83, 0
    buffer_load_dwordx4 v24, s[20:23], s80 offen lds
    v_mfma_f32_32x32x16_bf16 v[112:127], a[84:87], v[52:55], v[112:127]
    s_add_u32 m0, s86, 1024
    s_add_u32 s80, s83, 7168
    buffer_load_dwordx4 v24, s[20:23], s80 offen lds
    v_mfma_f32_32x32x16_bf16 v[64:79], a[88:91], v[56:59], v[64:79]
    ds_read_b128 v[48:51], v27 offset:13312
    ds_read_b128 v[52:55], v27 offset:41984
    s_waitcnt lgkmcnt(2)
    s_add_u32 m0, s86, 2048
    s_add_u32 s80, s83, 14336
    buffer_load_dwordx4 v24, s[20:23], s80 offen lds
    v_mfma_f32_32x32x16_bf16 v[80:95], a[88:91], v[60:63], v[80:95]
    s_waitcnt vmcnt(21)
    ds_read_b64_tr_b16 a[80:81], v2 offset:4096
    ds_read_b64_tr_b16 a[82:83], v2 offset:5120
    v_mfma_f32_32x32x16_bf16 v[96:111], a[92:95], v[56:59], v[96:111]
    s_add_u32 m0, s86, 3072
    s_add_u32 s80, s83, 21504
    buffer_load_dwordx4 v24, s[20:23], s80 offen lds
    v_mfma_f32_32x32x16_bf16 v[112:127], a[92:95], v[60:63], v[112:127]
    ds_read_b64_tr_b16 a[84:85], v3 offset:4096
    ds_read_b64_tr_b16 a[86:87], v3 offset:5120
    v_mfma_f32_32x32x16_bf16 v[64:79], a[96:99], v[40:43], v[64:79]
    ds_read_b128 v[56:59], v27 offset:14336
    ds_read_b128 v[60:63], v27 offset:43008
    s_waitcnt lgkmcnt(2)
    s_add_u32 s96, s96, 57344
    s_cmp_ge_u32 s96, 401408
    s_cselect_b32 s80, 401408, 0
    s_sub_u32 s96, s96, s80
    s_add_u32 s83, s96, s89
    s_add_u32 m0, s86, 4096
    s_add_u32 s80, s83, 0
    buffer_load_dwordx4 v24, s[20:23], s80 offen lds
    v_mfma_f32_32x32x16_bf16 v[80:95], a[96:99], v[44:47], v[80:95]
    s_waitcnt vmcnt(21)
    ds_read_b64_tr_b16 a[88:89], v2 offset:6144
    ds_read_b64_tr_b16 a[90:91], v2 offset:7168
    v_mfma_f32_32x32x16_bf16 v[96:111], a[100:103], v[40:43], v[96:111]
    s_add_u32 m0, s86, 5120
    s_add_u32 s80, s83, 7168
    buffer_load_dwordx4 v24, s[20:23], s80 offen lds
    v_mfma_f32_32x32x16_bf16 v[112:127], a[100:103], v[44:47], v[112:127]
    ds_read_b64_tr_b16 a[92:93], v3 offset:6144
    ds_read_b64_tr_b16 a[94:95], v3 offset:7168
    v_mov_b32 v4, 159780
    s_mov_b32 s90, 0
L_ls_33:
    ds_read_b32 v5, v4
    s_add_u32 s90, s90, 1
    s_waitcnt lgkmcnt(0)
    v_readfirstlane_b32 s100, v5
    s_cmp_ge_u32 s100, 4
    s_cbranch_scc1 L_lk_34
    s_cmp_lt_u32 s90, 400000
    s_cbranch_scc1 L_ls_33
L_lk_34:
    v_lshlrev_b32 v6, 3, v0
    v_add_u32 v6, 161792, v6
    ds_read_b64 v[32:33], v6 offset:0
    ds_read_b64 v[34:35], v6 offset:512
    ds_read_b64 v[36:37], v6 offset:1024
    ds_read_b64 v[38:39], v6 offset:1536
    v_mfma_f32_32x32x16_bf16 v[64:79], a[104:107], v[48:51], v[64:79]
    ds_read_b128 v[40:43], v27 offset:15360
    ds_read_b128 v[44:47], v27 offset:44032
    s_add_u32 m0, s86, 6144
    s_add_u32 s80, s83, 14336
    buffer_load_dwordx4 v24, s[20:23], s80 offen lds
    v_mfma_f32_32x32x16_bf16 v[80:95], a[104:107], v[52:55], v[80:95]
    s_lshl_b32 s80, s73, 6
    v_xor_b32 v2, s80, v2
    v_xor_b32 v3, s80, v3
    v_xor_b32 v25, s80, v25
    v_xor_b32 v31, s80, v31
    s_waitcnt vmcnt(21)
    ds_read_b64_tr_b16 a[96:97], v2 offset:8192
    ds_read_b64_tr_b16 a[98:99], v2 offset:9216
    v_mfma_f32_32x32x16_bf16 v[96:111], a[108:111], v[48:51], v[96:111]
    s_add_u32 m0, s86, 7168
    s_add_u32 s80, s83, 21504
    buffer_load_dwordx4 v24, s[20:23], s80 offen lds
    v_mfma_f32_32x32x16_bf16 v[112:127], a[108:111], v[52:55], v[112:127]
    ds_read_b64_tr_b16 a[100:101], v3 offset:8192
    ds_read_b64_tr_b16 a[102:103], v3 offset:9216
    v_mfma_f32_32x32x16_bf16 v[64:79], a[112:115], v[56:59], v[64:79]
    ds_read_b128 v[48:51], v27 offset:16384
    ds_read_b128 v[52:55], v27 offset:45056
    s_waitcnt lgkmcnt(2)
    s_add_u32 s96, s96, 57344
    s_cmp_ge_u32 s96, 401408
    s_cselect_b32 s80, 401408, 0
    s_sub_u32 s96, s96, s80
    s_add_u32 s83, s96, s89
    s_add_u32 m0, s86, 8192
    s_add_u32 s80, s83, 0
    buffer_load_dwordx4 v24, s[20:23], s80 offen lds
    v_mfma_f32_32x32x16_bf16 v[80:95], a[112:115], v[60:63], v[80:95]
    s_waitcnt vmcnt(21)
    ds_read_b64_tr_b16 a[104:105], v2 offset:10240
    ds_read_b64_tr_b16 a[106:107], v2 offset:11264
    v_mfma_f32_32x32x16_bf16 v[96:111], a[116:119], v[56:59], v[96:111]
    s_add_u32 m0, s86, 9216
    s_add_u32 s80, s83, 7168
    buffer_load_dwordx4 v24, s[20:23], s80 offen lds
    v_mfma_f32_32x32x16_bf16 v[112:127], a[116:119], v[60:63], v[112:127]
    ds_read_b64_tr_b16 a[108:109], v3 offset:10240
    ds_read_b64_tr_b16 a[110:111], v3 offset:11264
    v_mfma_f32_32x32x16_bf16 v[64:79], a[120:123], v[40:43], v[64:79]
    ds_read_b128 v[56:59], v27 offset:17408
    ds_read_b128 v[60:63], v27 offset:46080
    s_waitcnt lgkmcnt(2)
    s_add_u32 m0, s86, 10240
    s_add_u32 s80, s83, 14336
    buffer_load_dwordx4 v24, s[20:23], s80 offen lds
    v_mfma_f32_32x32x16_bf16 v[80:95], a[120:123], v[44:47], v[80:95]
    s_waitcnt vmcnt(21)
    ds_read_b64_tr_b16 a[112:113], v2 offset:12288
    ds_read_b64_tr_b16 a[114:115], v2 offset:13312
    v_mfma_f32_32x32x16_bf16 v[96:111], a[124:127], v[40:43], v[96:111]
    s_add_u32 m0, s86, 11264
    s_add_u32 s80, s83, 21504
    buffer_load_dwordx4 v24, s[20:23], s80 offen lds
    v_mfma_f32_32x32x16_bf16 v[112:127], a[124:127], v[44:47], v[112:127]
    ds_read_b64_tr_b16 a[116:117], v3 offset:12288
    ds_read_b64_tr_b16 a[118:119], v3 offset:13312
    v_mfma_f32_32x32x16_bf16 v[64:79], a[0:3], v[48:51], v[64:79]
    ds_read_b128 v[40:43], v27 offset:18432
    ds_read_b128 v[44:47], v27 offset:47104
    s_waitcnt lgkmcnt(2)
    s_mul_i32 s96, s93, 57344
    s_add_u32 s83, s96, s89
    s_add_u32 m0, s86, 12288
    s_add_u32 s80, s83, 28672
    buffer_load_dwordx4 v24, s[20:23], s80 offen lds
    v_mfma_f32_32x32x16_bf16 v[80:95], a[0:3], v[52:55], v[80:95]
    s_waitcnt vmcnt(21)
    ds_read_b64_tr_b16 a[120:121], v25 offset:0
    ds_read_b64_tr_b16 a[122:123], v25 offset:1024
    v_mfma_f32_32x32x16_bf16 v[96:111], a[4:7], v[48:51], v[96:111]
    s_add_u32 m0, s86, 13312
    s_add_u32 s80, s83, 35840
    buffer_load_dwordx4 v24, s[20:23], s80 offen lds
    v_mfma_f32_32x32x16_bf16 v[112:127], a[4:7], v[52:55], v[112:127]
    ds_read_b64_tr_b16 a[124:125], v31 offset:0
    ds_read_b64_tr_b16 a[126:127], v31 offset:1024
    v_add_f32 v32, v32, v34
    v_add_f32 v33, v33, v35
    v_add_f32 v36, v36, v38
    v_add_f32 v37, v37, v39
    v_add_f32 v32, v32, v36
    v_add_f32 v33, v33, v37
    v_add_f32 v28, v28, v29
    v_mfma_f32_32x32x16_bf16 v[64:79], a[8:11], v[56:59], v[64:79]
    ds_read_b128 v[48:51], v27 offset:19456
    ds_read_b128 v[52:55], v27 offset:48128
    s_waitcnt lgkmcnt(2)
    s_add_u32 m0, s87, 0
    s_add_u32 s80, s83, 43008
    buffer_load_dwordx4 v24, s[20:23], s80 offen lds
    v_mfma_f32_32x32x16_bf16 v[80:95], a[8:11], v[60:63], v[80:95]
    s_waitcnt vmcnt(21)
    ds_read_b64_tr_b16 a[0:1], v25 offset:2048
    ds_read_b64_tr_b16 a[2:3], v25 offset:3072
    v_mfma_f32_32x32x16_bf16 v[96:111], a[12:15], v[56:59], v[96:111]
    s_add_u32 m0, s87, 1024
    s_add_u32 s80, s83, 50176
    buffer_load_dwordx4 v24, s[20:23], s80 offen lds
    v_mfma_f32_32x32x16_bf16 v[112:127], a[12:15], v[60:63], v[112:127]
    ds_read_b64_tr_b16 a[4:5], v31 offset:2048
    ds_read_b64_tr_b16 a[6:7], v31 offset:3072
    v_mul_f32 v32, 0xbb124925, v32
    v_mul_f32 v33, 0x3b124925, v33
    v_mul_f32 v34, v32, v32
    v_sub_f32 v33, v33, v34
    v_max_f32 v33, 0, v33
    v_add_f32 v33, 0x3727c5ac, v33
    v_mfma_f32_32x32x16_bf16 v[64:79], a[16:19], v[40:43], v[64:79]
    ds_read_b128 v[56:59], v27 offset:20480
    ds_read_b128 v[60:63], v27 offset:49152
    s_waitcnt lgkmcnt(2)
    s_add_u32 s96, s96, 57344
    s_cmp_ge_u32 s96, 401408
    s_cselect_b32 s80, 401408, 0
    s_sub_u32 s96, s96, s80
    s_add_u32 s83, s96, s89
    s_add_u32 m0, s87, 2048
    s_add_u32 s80, s83, 28672
    buffer_load_dwordx4 v24, s[20:23], s80 offen lds
    v_mfma_f32_32x32x16_bf16 v[80:95], a[16:19], v[44:47], v[80:95]
    s_waitcnt vmcnt(21)
    ds_read_b64_tr_b16 a[8:9], v25 offset:4096
    ds_read_b64_tr_b16 a[10:11], v25 offset:5120
    v_mfma_f32_32x32x16_bf16 v[96:111], a[20:23], v[40:43], v[96:111]
    s_add_u32 m0, s87, 3072
    s_add_u32 s80, s83, 35840
    buffer_load_dwordx4 v24, s[20:23], s80 offen lds
    v_mfma_f32_32x32x16_bf16 v[112:127], a[20:23], v[44:47], v[112:127]
    ds_read_b64_tr_b16 a[12:13], v31 offset:4096
    ds_read_b64_tr_b16 a[14:15], v31 offset:5120
    v_mov_b32 v34, v32
    s_nop 1
    v_permlane32_swap_b32 v32, v34
    v_mov_b32 v35, v33
    s_nop 1
    v_permlane32_swap_b32 v33, v35
    v_mov_b32 v29, v28
    s_nop 1
    v_permlane32_swap_b32 v28, v29
    v_mfma_f32_32x32x16_bf16 v[64:79], a[24:27], v[48:51], v[64:79]
    ds_read_b128 v[40:43], v27 offset:21504
    ds_read_b128 v[44:47], v27 offset:50176
    s_waitcnt lgkmcnt(2)
    s_add_u32 m0, s87, 4096
    s_add_u32 s80, s83, 43008
    buffer_load_dwordx4 v24, s[20:23], s80 offen lds
    v_mfma_f32_32x32x16_bf16 v[80:95], a[24:27], v[52:55], v[80:95]
    s_waitcnt vmcnt(21)
    ds_read_b64_tr_b16 a[16:17], v25 offset:6144
    ds_read_b64_tr_b16 a[18:19], v25 offset:7168
    v_mfma_f32_32x32x16_bf16 v[96:111], a[28:31], v[48:51], v[96:111]
    s_add_u32 m0, s87, 5120
    s_add_u32 s80, s83, 50176
    buffer_load_dwordx4 v24, s[20:23], s80 offen lds
    v_mfma_f32_32x32x16_bf16 v[112:127], a[28:31], v[52:55], v[112:127]
    ds_read_b64_tr_b16 a[20:21], v31 offset:6144
    ds_read_b64_tr_b16 a[22:23], v31 offset:7168
    v_mfma_f32_32x32x16_bf16 v[64:79], a[32:35], v[56:59], v[64:79]
    ds_read_b128 v[48:51], v27 offset:22528
    ds_read_b128 v[52:55], v27 offset:51200
    s_waitcnt lgkmcnt(2)
    s_add_u32 s96, s96, 57344
    s_cmp_ge_u32 s96, 401408
    s_cselect_b32 s80, 401408, 0
    s_sub_u32 s96, s96, s80
    s_add_u32 s83, s96, s89
    s_add_u32 m0, s87, 6144
    s_add_u32 s80, s83, 28672
    buffer_load_dwordx4 v24, s[20:23], s80 offen lds
    v_mfma_f32_32x32x16_bf16 v[80:95], a[32:35], v[60:63], v[80:95]
    s_waitcnt vmcnt(21)
    ds_read_b64_tr_b16 a[24:25], v25 offset:8192
    ds_read_b64_tr_b16 a[26:27], v25 offset:9216
    v_mfma_f32_32x32x16_bf16 v[96:111], a[36:39], v[56:59], v[96:111]
    s_add_u32 m0, s87, 7168
    s_add_u32 s80, s83, 35840
    buffer_load_dwordx4 v24, s[20:23], s80 offen lds
    v_mfma_f32_32x32x16_bf16 v[112:127], a[36:39], v[60:63], v[112:127]
    ds_read_b64_tr_b16 a[28:29], v31 offset:8192
    ds_read_b64_tr_b16 a[30:31], v31 offset:9216
    v_mfma_f32_32x32x16_bf16 v[64:79], a[40:43], v[40:43], v[64:79]
    ds_read_b128 v[56:59], v27 offset:23552
    ds_read_b128 v[60:63], v27 offset:52224
    s_waitcnt lgkmcnt(2)
    s_add_u32 m0, s87, 8192
    s_add_u32 s80, s83, 43008
    buffer_load_dwordx4 v24, s[20:23], s80 offen lds
    v_mfma_f32_32x32x16_bf16 v[80:95], a[40:43], v[44:47], v[80:95]
    s_waitcnt vmcnt(21)
    ds_read_b64_tr_b16 a[32:33], v2 offset:0
    ds_read_b64_tr_b16 a[34:35], v2 offset:1024
    v_mfma_f32_32x32x16_bf16 v[96:111], a[44:47], v[40:43], v[96:111]
    s_add_u32 m0, s87, 9216
    s_add_u32 s80, s83, 50176
    buffer_load_dwordx4 v24, s[20:23], s80 offen lds
    v_mfma_f32_32x32x16_bf16 v[112:127], a[44:47], v[44:47], v[112:127]
    ds_read_b64_tr_b16 a[36:37], v3 offset:0
    ds_read_b64_tr_b16 a[38:39], v3 offset:1024
    v_mfma_f32_32x32x16_bf16 v[64:79], a[48:51], v[48:51], v[64:79]
    ds_read_b128 v[40:43], v27 offset:24576
    ds_read_b128 v[44:47], v27 offset:53248
    s_waitcnt lgkmcnt(2)
    s_add_u32 s96, s96, 57344
    s_cmp_ge_u32 s96, 401408
    s_cselect_b32 s80, 401408, 0
    s_sub_u32 s96, s96, s80
    s_add_u32 s83, s96, s89
    s_add_u32 m0, s86, 0
    s_add_u32 s80, s83, 28672
    buffer_load_dwordx4 v24, s[20:23], s80 offen lds
    v_mfma_f32_32x32x16_bf16 v[80:95], a[48:51], v[52:55], v[80:95]
    s_waitcnt vmcnt(21)
    ds_read_b64_tr_b16 a[40:41], v2 offset:2048
    ds_read_b64_tr_b16 a[42:43], v2 offset:3072
    v_mfma_f32_32x32x16_bf16 v[96:111], a[52:55], v[48:51], v[96:111]
    s_add_u32 m0, s86, 1024
    s_add_u32 s80, s83, 35840
    buffer_load_dwordx4 v24, s[20:23], s80 offen lds
    v_mfma_f32_32x32x16_bf16 v[112:127], a[52:55], v[52:55], v[112:127]
    ds_read_b64_tr_b16 a[44:45], v3 offset:2048
    ds_read_b64_tr_b16 a[46:47], v3 offset:3072
    v_mfma_f32_32x32x16_bf16 v[64:79], a[56:59], v[56:59], v[64:79]
    ds_read_b128 v[48:51], v27 offset:25600
    ds_read_b128 v[52:55], v27 offset:54272
    s_waitcnt lgkmcnt(2)
    s_add_u32 m0, s86, 2048
    s_add_u32 s80, s83, 43008
    buffer_load_dwordx4 v24, s[20:23], s80 offen lds
    v_mfma_f32_32x32x16_bf16 v[80:95], a[56:59], v[60:63], v[80:95]
    s_waitcnt vmcnt(21)
    ds_read_b64_tr_b16 a[48:49], v2 offset:4096
    ds_read_b64_tr_b16 a[50:51], v2 offset:5120
    v_mfma_f32_32x32x16_bf16 v[96:111], a[60:63], v[56:59], v[96:111]
    s_add_u32 m0, s86, 3072
    s_add_u32 s80, s83, 50176
    buffer_load_dwordx4 v24, s[20:23], s80 offen lds
    v_mfma_f32_32x32x16_bf16 v[112:127], a[60:63], v[60:63], v[112:127]
    ds_read_b64_tr_b16 a[52:53], v3 offset:4096
    ds_read_b64_tr_b16 a[54:55], v3 offset:5120
    v_mfma_f32_32x32x16_bf16 v[64:79], a[64:67], v[40:43], v[64:79]
    ds_read_b128 v[56:59], v27 offset:26624
    ds_read_b128 v[60:63], v27 offset:55296
    s_waitcnt lgkmcnt(2)
    s_add_u32 s96, s96, 57344
    s_cmp_ge_u32 s96, 401408
    s_cselect_b32 s80, 401408, 0
    s_sub_u32 s96, s96, s80
    s_add_u32 s83, s96, s89
    s_add_u32 m0, s86, 4096
    s_add_u32 s80, s83, 28672
    buffer_load_dwordx4 v24, s[20:23], s80 offen lds
    v_mfma_f32_32x32x16_bf16 v[80:95], a[64:67], v[44:47], v[80:95]
    s_waitcnt vmcnt(21)
    ds_read_b64_tr_b16 a[56:57], v2 offset:6144
    ds_read_b64_tr_b16 a[58:59], v2 offset:7168
    v_mfma_f32_32x32x16_bf16 v[96:111], a[68:71], v[40:43], v[96:111]
    s_add_u32 m0, s86, 5120
    s_add_u32 s80, s83, 35840
    buffer_load_dwordx4 v24, s[20:23], s80 offen lds
    v_mfma_f32_32x32x16_bf16 v[112:127], a[68:71], v[44:47], v[112:127]
    ds_read_b64_tr_b16 a[60:61], v3 offset:6144
    ds_read_b64_tr_b16 a[62:63], v3 offset:7168
    v_mfma_f32_32x32x16_bf16 v[64:79], a[72:75], v[48:51], v[64:79]
    ds_read_b128 v[40:43], v27 offset:27648
    ds_read_b128 v[44:47], v27 offset:56320
    s_waitcnt lgkmcnt(2)
    s_add_u32 m0, s86, 6144
    s_add_u32 s80, s83, 43008
    buffer_load_dwordx4 v24, s[20:23], s80 offen lds
    v_mfma_f32_32x32x16_bf16 v[80:95], a[72:75], v[52:55], v[80:95]
    s_waitcnt vmcnt(21)
    ds_read_b64_tr_b16 a[64:65], v2 offset:8192
    ds_read_b64_tr_b16 a[66:67], v2 offset:9216
    v_mfma_f32_32x32x16_bf16 v[96:111], a[76:79], v[48:51], v[96:111]
    s_add_u32 m0, s86, 7168
    s_add_u32 s80, s83, 50176
    buffer_load_dwordx4 v24, s[20:23], s80 offen lds
    v_mfma_f32_32x32x16_bf16 v[112:127], a[76:79], v[52:55], v[112:127]
    ds_read_b64_tr_b16 a[68:69], v3 offset:8192
    ds_read_b64_tr_b16 a[70:71], v3 offset:9216
    v_mfma_f32_32x32x16_bf16 v[64:79], a[80:83], v[56:59], v[64:79]
    s_waitcnt lgkmcnt(0)
    s_add_u32 s96, s96, 57344
    s_cmp_ge_u32 s96, 401408
    s_cselect_b32 s80, 401408, 0
    s_sub_u32 s96, s96, s80
    s_add_u32 s83, s96, s89
    s_add_u32 m0, s86, 8192
    s_add_u32 s80, s83, 28672
    buffer_load_dwordx4 v24, s[20:23], s80 offen lds
    v_mfma_f32_32x32x16_bf16 v[80:95], a[80:83], v[60:63], v[80:95]
    s_waitcnt vmcnt(21)
    ds_read_b64_tr_b16 a[72:73], v2 offset:10240
    ds_read_b64_tr_b16 a[74:75], v2 offset:11264
    v_mfma_f32_32x32x16_bf16 v[96:111], a[84:87], v[56:59], v[96:111]
    s_add_u32 m0, s86, 9216
    s_add_u32 s80, s83, 35840
    buffer_load_dwordx4 v24, s[20:23], s80 offen lds
    v_mfma_f32_32x32x16_bf16 v[112:127], a[84:87], v[60:63], v[112:127]
    ds_read_b64_tr_b16 a[76:77], v3 offset:10240
    ds_read_b64_tr_b16 a[78:79], v3 offset:11264
    v_mfma_f32_32x32x16_bf16 v[64:79], a[88:91], v[40:43], v[64:79]
    s_waitcnt lgkmcnt(0)
    s_add_u32 m0, s86, 10240
    s_add_u32 s80, s83, 43008
    buffer_load_dwordx4 v24, s[20:23], s80 offen lds
    v_mfma_f32_32x32x16_bf16 v[80:95], a[88:91], v[44:47], v[80:95]
    s_waitcnt vmcnt(21)
    ds_read_b64_tr_b16 a[80:81], v2 offset:12288
    ds_read_b64_tr_b16 a[82:83], v2 offset:13312
    v_mfma_f32_32x32x16_bf16 v[96:111], a[92:95], v[40:43], v[96:111]
    s_add_u32 m0, s86, 11264
    s_add_u32 s80, s83, 50176
    buffer_load_dwordx4 v24, s[20:23], s80 offen lds
    v_mfma_f32_32x32x16_bf16 v[112:127], a[92:95], v[44:47], v[112:127]
    ds_read_b64_tr_b16 a[84:85], v3 offset:12288
    ds_read_b64_tr_b16 a[86:87], v3 offset:13312
    s_mov_b64 exec, 1
    v_mov_b32 v4, 159784
    v_mov_b32 v5, 1
    ds_add_u32 v4, v5
    s_mov_b64 exec, -1
    v_cvt_pk_bf16_f32 v4, v28, v28
    v_and_b32 v5, 0xffff0000, v4
    v_sub_f32 v5, v28, v5
    v_cvt_pk_bf16_f32 v40, v28, v5
    v_and_b32 v41, 0xffff, v4
    v_mov_b32 v42, 0
    v_mov_b32 v43, 0
    v_cvt_pk_bf16_f32 v4, v29, v29
    v_and_b32 v5, 0xffff0000, v4
    v_sub_f32 v5, v29, v5
    v_cvt_pk_bf16_f32 v44, v29, v5
    v_and_b32 v45, 0xffff, v4
    v_mov_b32 v46, 0
    v_mov_b32 v47, 0
    v_cvt_pk_bf16_f32 v4, v32, v32
    v_and_b32 v5, 0xffff0000, v4
    v_sub_f32 v5, v32, v5
    v_cvt_pk_bf16_f32 v5, v5, 0
    v_cndmask_b32 v48, v4, 0, s[76:77]
    v_cndmask_b32 v49, v5, 0, s[76:77]
    v_mov_b32 v50, 0
    v_mov_b32 v51, 0
    v_cvt_pk_bf16_f32 v4, v34, v34
    v_and_b32 v5, 0xffff0000, v4
    v_sub_f32 v5, v34, v5
    v_cvt_pk_bf16_f32 v5, v5, 0
    v_cndmask_b32 v52, v4, 0, s[76:77]
    v_cndmask_b32 v53, v5, 0, s[76:77]
    v_mov_b32 v54, 0
    v_mov_b32 v55, 0
    s_nop 0
    v_mfma_f32_32x32x16_bf16 v[64:79], v[40:43], v[48:51], v[64:79]
    v_mfma_f32_32x32x16_bf16 v[80:95], v[40:43], v[52:55], v[80:95]
    v_mfma_f32_32x32x16_bf16 v[96:111], v[44:47], v[48:51], v[96:111]
    v_mfma_f32_32x32x16_bf16 v[112:127], v[44:47], v[52:55], v[112:127]
    v_rsq_f32 v4, v33
    s_nop 0
    v_mul_f32 v62, v33, v4
    v_mul_f32 v60, 0xc0135761, v4
    v_mul_f32 v61, v4, v4
    v_mul_f32 v61, v61, v4
    v_mul_f32 v61, 0xbdd2d3e8, v61
    v_rsq_f32 v4, v35
    s_nop 0
    v_mul_f32 v38, v35, v4
    v_mul_f32 v36, 0xc0135761, v4
    v_mul_f32 v37, v4, v4
    v_mul_f32 v37, v37, v4
    v_mul_f32 v37, 0xbdd2d3e8, v37
    v_mul_f32 v56, v64, v64
    v_mul_f32 v57, v65, v65
    v_fma_f32 v56, v56, v61, v60
    v_fma_f32 v57, v57, v61, v60
    v_mul_f32 v56, v56, v64
    v_mul_f32 v57, v57, v65
    v_exp_f32 v56, v56
    v_exp_f32 v57, v57
    v_fma_f32 v56, v56, v62, v62
    v_fma_f32 v57, v57, v62, v62
    v_rcp_f32 v56, v56
    v_rcp_f32 v57, v57
    v_mul_f32 v56, v56, v64
    v_mul_f32 v57, v57, v65
    v_cvt_pk_bf16_f32 v40, v56, v57
    v_mul_f32 v56, v66, v66
    v_mul_f32 v57, v67, v67
    v_fma_f32 v56, v56, v61, v60
    v_fma_f32 v57, v57, v61, v60
    v_mul_f32 v56, v56, v66
    v_mul_f32 v57, v57, v67
    v_exp_f32 v56, v56
    v_exp_f32 v57, v57
    v_fma_f32 v56, v56, v62, v62
    v_fma_f32 v57, v57, v62, v62
    v_rcp_f32 v56, v56
    v_rcp_f32 v57, v57
    v_mul_f32 v56, v56, v66
    v_mul_f32 v57, v57, v67
    v_cvt_pk_bf16_f32 v41, v56, v57
    v_mul_f32 v56, v68, v68
    v_mul_f32 v57, v69, v69
    v_fma_f32 v56, v56, v61, v60
    v_fma_f32 v57, v57, v61, v60
    v_mul_f32 v56, v56, v68
    v_mul_f32 v57, v57, v69
    v_exp_f32 v56, v56
    v_exp_f32 v57, v57
    v_fma_f32 v56, v56, v62, v62
    v_fma_f32 v57, v57, v62, v62
    v_rcp_f32 v56, v56
    v_rcp_f32 v57, v57
    v_mul_f32 v56, v56, v68
    v_mul_f32 v57, v57, v69
    v_cvt_pk_bf16_f32 v42, v56, v57
    v_mul_f32 v56, v70, v70
    v_mul_f32 v57, v71, v71
    v_fma_f32 v56, v56, v61, v60
    v_fma_f32 v57, v57, v61, v60
    v_mul_f32 v56, v56, v70
    v_mul_f32 v57, v57, v71
    v_exp_f32 v56, v56
    v_exp_f32 v57, v57
    v_fma_f32 v56, v56, v62, v62
    v_fma_f32 v57, v57, v62, v62
    v_rcp_f32 v56, v56
    v_rcp_f32 v57, v57
    v_mul_f32 v56, v56, v70
    v_mul_f32 v57, v57, v71
    v_cvt_pk_bf16_f32 v43, v56, v57
    s_add_u32 s80, s91, 0
    buffer_store_dwordx4 v[40:43], v1, s[16:19], s80 offen offset:0 sc1
    v_mul_f32 v56, v72, v72
    v_mul_f32 v57, v73, v73
    v_fma_f32 v56, v56, v61, v60
    v_fma_f32 v57, v57, v61, v60
    v_mul_f32 v56, v56, v72
    v_mul_f32 v57, v57, v73
    v_exp_f32 v56, v56
    v_exp_f32 v57, v57
    v_fma_f32 v56, v56, v62, v62
    v_fma_f32 v57, v57, v62, v62
    v_rcp_f32 v56, v56
    v_rcp_f32 v57, v57
    v_mul_f32 v56, v56, v72
    v_mul_f32 v57, v57, v73
    v_cvt_pk_bf16_f32 v44, v56, v57
    v_mul_f32 v56, v74, v74
    v_mul_f32 v57, v75, v75
    v_fma_f32 v56, v56, v61, v60
    v_fma_f32 v57, v57, v61, v60
    v_mul_f32 v56, v56, v74
    v_mul_f32 v57, v57, v75
    v_exp_f32 v56, v56
    v_exp_f32 v57, v57
    v_fma_f32 v56, v56, v62, v62
    v_fma_f32 v57, v57, v62, v62
    v_rcp_f32 v56, v56
    v_rcp_f32 v57, v57
    v_mul_f32 v56, v56, v74
    v_mul_f32 v57, v57, v75
    v_cvt_pk_bf16_f32 v45, v56, v57
    v_mul_f32 v56, v76, v76
    v_mul_f32 v57, v77, v77
    v_fma_f32 v56, v56, v61, v60
    v_fma_f32 v57, v57, v61, v60
    v_mul_f32 v56, v56, v76
    v_mul_f32 v57, v57, v77
    v_exp_f32 v56, v56
    v_exp_f32 v57, v57
    v_fma_f32 v56, v56, v62, v62
    v_fma_f32 v57, v57, v62, v62
    v_rcp_f32 v56, v56
    v_rcp_f32 v57, v57
    v_mul_f32 v56, v56, v76
    v_mul_f32 v57, v57, v77
    v_cvt_pk_bf16_f32 v46, v56, v57
    v_mul_f32 v56, v78, v78
    v_mul_f32 v57, v79, v79
    v_fma_f32 v56, v56, v61, v60
    v_fma_f32 v57, v57, v61, v60
    v_mul_f32 v56, v56, v78
    v_mul_f32 v57, v57, v79
    v_exp_f32 v56, v56
    v_exp_f32 v57, v57
    v_fma_f32 v56, v56, v62, v62
    v_fma_f32 v57, v57, v62, v62
    v_rcp_f32 v56, v56
    v_rcp_f32 v57, v57
    v_mul_f32 v56, v56, v78
    v_mul_f32 v57, v57, v79
    v_cvt_pk_bf16_f32 v47, v56, v57
    s_add_u32 s80, s91, 0
    buffer_store_dwordx4 v[44:47], v1, s[16:19], s80 offen offset:1024 sc1
    v_mul_f32 v56, v80, v80
    v_mul_f32 v57, v81, v81
    v_fma_f32 v56, v56, v37, v36
    v_fma_f32 v57, v57, v37, v36
    v_mul_f32 v56, v56, v80
    v_mul_f32 v57, v57, v81
    v_exp_f32 v56, v56
    v_exp_f32 v57, v57
    v_fma_f32 v56, v56, v38, v38
    v_fma_f32 v57, v57, v38, v38
    v_rcp_f32 v56, v56
    v_rcp_f32 v57, v57
    v_mul_f32 v56, v56, v80
    v_mul_f32 v57, v57, v81
    v_cvt_pk_bf16_f32 v48, v56, v57
    v_mul_f32 v56, v82, v82
    v_mul_f32 v57, v83, v83
    v_fma_f32 v56, v56, v37, v36
    v_fma_f32 v57, v57, v37, v36
    v_mul_f32 v56, v56, v82
    v_mul_f32 v57, v57, v83
    v_exp_f32 v56, v56
    v_exp_f32 v57, v57
    v_fma_f32 v56, v56, v38, v38
    v_fma_f32 v57, v57, v38, v38
    v_rcp_f32 v56, v56
    v_rcp_f32 v57, v57
    v_mul_f32 v56, v56, v82
    v_mul_f32 v57, v57, v83
    v_cvt_pk_bf16_f32 v49, v56, v57
    v_mul_f32 v56, v84, v84
    v_mul_f32 v57, v85, v85
    v_fma_f32 v56, v56, v37, v36
    v_fma_f32 v57, v57, v37, v36
    v_mul_f32 v56, v56, v84
    v_mul_f32 v57, v57, v85
    v_exp_f32 v56, v56
    v_exp_f32 v57, v57
    v_fma_f32 v56, v56, v38, v38
    v_fma_f32 v57, v57, v38, v38
    v_rcp_f32 v56, v56
    v_rcp_f32 v57, v57
    v_mul_f32 v56, v56, v84
    v_mul_f32 v57, v57, v85
    v_cvt_pk_bf16_f32 v50, v56, v57
    v_mul_f32 v56, v86, v86
    v_mul_f32 v57, v87, v87
    v_fma_f32 v56, v56, v37, v36
    v_fma_f32 v57, v57, v37, v36
    v_mul_f32 v56, v56, v86
    v_mul_f32 v57, v57, v87
    v_exp_f32 v56, v56
    v_exp_f32 v57, v57
    v_fma_f32 v56, v56, v38, v38
    v_fma_f32 v57, v57, v38, v38
    v_rcp_f32 v56, v56
    v_rcp_f32 v57, v57
    v_mul_f32 v56, v56, v86
    v_mul_f32 v57, v57, v87
    v_cvt_pk_bf16_f32 v51, v56, v57
    s_waitcnt lgkmcnt(1)
    s_add_u32 s96, s96, 57344
    s_cmp_ge_u32 s96, 401408
    s_cselect_b32 s80, 401408, 0
    s_sub_u32 s96, s96, s80
    s_add_u32 s83, s96, s89
    s_add_u32 m0, s86, 12288
    s_add_u32 s80, s83, 28672
    buffer_load_dwordx4 v24, s[20:23], s80 offen lds
    s_add_u32 s80, s91, 114688
    buffer_store_dwordx4 v[48:51], v1, s[16:19], s80 offen offset:0 sc1
    v_mul_f32 v56, v88, v88
    v_mul_f32 v57, v89, v89
    v_fma_f32 v56, v56, v37, v36
    v_fma_f32 v57, v57, v37, v36
    v_mul_f32 v56, v56, v88
    v_mul_f32 v57, v57, v89
    v_exp_f32 v56, v56
    v_exp_f32 v57, v57
    v_fma_f32 v56, v56, v38, v38
    v_fma_f32 v57, v57, v38, v38
    v_rcp_f32 v56, v56
    v_rcp_f32 v57, v57
    v_mul_f32 v56, v56, v88
    v_mul_f32 v57, v57, v89
    v_cvt_pk_bf16_f32 v52, v56, v57
    v_mul_f32 v56, v90, v90
    v_mul_f32 v57, v91, v91
    v_fma_f32 v56, v56, v37, v36
    v_fma_f32 v57, v57, v37, v36
    v_mul_f32 v56, v56, v90
    v_mul_f32 v57, v57, v91
    v_exp_f32 v56, v56
    v_exp_f32 v57, v57
    v_fma_f32 v56, v56, v38, v38
    v_fma_f32 v57, v57, v38, v38
    v_rcp_f32 v56, v56
    v_rcp_f32 v57, v57
    v_mul_f32 v56, v56, v90
    v_mul_f32 v57, v57, v91
    v_cvt_pk_bf16_f32 v53, v56, v57
    v_mul_f32 v56, v92, v92
    v_mul_f32 v57, v93, v93
    v_fma_f32 v56, v56, v37, v36
    v_fma_f32 v57, v57, v37, v36
    v_mul_f32 v56, v56, v92
    v_mul_f32 v57, v57, v93
    v_exp_f32 v56, v56
    v_exp_f32 v57, v57
    v_fma_f32 v56, v56, v38, v38
    v_fma_f32 v57, v57, v38, v38
    v_rcp_f32 v56, v56
    v_rcp_f32 v57, v57
    v_mul_f32 v56, v56, v92
    v_mul_f32 v57, v57, v93
    v_cvt_pk_bf16_f32 v54, v56, v57
    v_mul_f32 v56, v94, v94
    v_mul_f32 v57, v95, v95
    v_fma_f32 v56, v56, v37, v36
    v_fma_f32 v57, v57, v37, v36
    v_mul_f32 v56, v56, v94
    v_mul_f32 v57, v57, v95
    v_exp_f32 v56, v56
    v_exp_f32 v57, v57
    v_fma_f32 v56, v56, v38, v38
    v_fma_f32 v57, v57, v38, v38
    v_rcp_f32 v56, v56
    v_rcp_f32 v57, v57
    v_mul_f32 v56, v56, v94
    v_mul_f32 v57, v57, v95
    v_cvt_pk_bf16_f32 v55, v56, v57
    s_add_u32 s80, s91, 114688
    buffer_store_dwordx4 v[52:55], v1, s[16:19], s80 offen offset:1024 sc1
    v_mul_f32 v56, v96, v96
    v_mul_f32 v57, v97, v97
    v_fma_f32 v56, v56, v61, v60
    v_fma_f32 v57, v57, v61, v60
    v_mul_f32 v56, v56, v96
    v_mul_f32 v57, v57, v97
    v_exp_f32 v56, v56
    v_exp_f32 v57, v57
    v_fma_f32 v56, v56, v62, v62
    v_fma_f32 v57, v57, v62, v62
    v_rcp_f32 v56, v56
    v_rcp_f32 v57, v57
    v_mul_f32 v56, v56, v96
    v_mul_f32 v57, v57, v97
    v_cvt_pk_bf16_f32 v40, v56, v57
    v_mul_f32 v56, v98, v98
    v_mul_f32 v57, v99, v99
    v_fma_f32 v56, v56, v61, v60
    v_fma_f32 v57, v57, v61, v60
    v_mul_f32 v56, v56, v98
    v_mul_f32 v57, v57, v99
    v_exp_f32 v56, v56
    v_exp_f32 v57, v57
    v_fma_f32 v56, v56, v62, v62
    v_fma_f32 v57, v57, v62, v62
    v_rcp_f32 v56, v56
    v_rcp_f32 v57, v57
    v_mul_f32 v56, v56, v98
    v_mul_f32 v57, v57, v99
    v_cvt_pk_bf16_f32 v41, v56, v57
    v_mul_f32 v56, v100, v100
    v_mul_f32 v57, v101, v101
    v_fma_f32 v56, v56, v61, v60
    v_fma_f32 v57, v57, v61, v60
    v_mul_f32 v56, v56, v100
    v_mul_f32 v57, v57, v101
    v_exp_f32 v56, v56
    v_exp_f32 v57, v57
    v_fma_f32 v56, v56, v62, v62
    v_fma_f32 v57, v57, v62, v62
    v_rcp_f32 v56, v56
    v_rcp_f32 v57, v57
    v_mul_f32 v56, v56, v100
    v_mul_f32 v57, v57, v101
    v_cvt_pk_bf16_f32 v42, v56, v57
    v_mul_f32 v56, v102, v102
    v_mul_f32 v57, v103, v103
    v_fma_f32 v56, v56, v61, v60
    v_fma_f32 v57, v57, v61, v60
    v_mul_f32 v56, v56, v102
    v_mul_f32 v57, v57, v103
    v_exp_f32 v56, v56
    v_exp_f32 v57, v57
    v_fma_f32 v56, v56, v62, v62
    v_fma_f32 v57, v57, v62, v62
    v_rcp_f32 v56, v56
    v_rcp_f32 v57, v57
    v_mul_f32 v56, v56, v102
    v_mul_f32 v57, v57, v103
    v_cvt_pk_bf16_f32 v43, v56, v57
    s_add_u32 s80, s91, 2048
    buffer_store_dwordx4 v[40:43], v1, s[16:19], s80 offen offset:0 sc1
    v_mul_f32 v56, v104, v104
    v_mul_f32 v57, v105, v105
    v_fma_f32 v56, v56, v61, v60
    v_fma_f32 v57, v57, v61, v60
    v_mul_f32 v56, v56, v104
    v_mul_f32 v57, v57, v105
    v_exp_f32 v56, v56
    v_exp_f32 v57, v57
    v_fma_f32 v56, v56, v62, v62
    v_fma_f32 v57, v57, v62, v62
    v_rcp_f32 v56, v56
    v_rcp_f32 v57, v57
    v_mul_f32 v56, v56, v104
    v_mul_f32 v57, v57, v105
    v_cvt_pk_bf16_f32 v44, v56, v57
    v_mul_f32 v56, v106, v106
    v_mul_f32 v57, v107, v107
    v_fma_f32 v56, v56, v61, v60
    v_fma_f32 v57, v57, v61, v60
    v_mul_f32 v56, v56, v106
    v_mul_f32 v57, v57, v107
    v_exp_f32 v56, v56
    v_exp_f32 v57, v57
    v_fma_f32 v56, v56, v62, v62
    v_fma_f32 v57, v57, v62, v62
    v_rcp_f32 v56, v56
    v_rcp_f32 v57, v57
    v_mul_f32 v56, v56, v106
    v_mul_f32 v57, v57, v107
    v_cvt_pk_bf16_f32 v45, v56, v57
    v_mul_f32 v56, v108, v108
    v_mul_f32 v57, v109, v109
    v_fma_f32 v56, v56, v61, v60
    v_fma_f32 v57, v57, v61, v60
    v_mul_f32 v56, v56, v108
    v_mul_f32 v57, v57, v109
    v_exp_f32 v56, v56
    v_exp_f32 v57, v57
    v_fma_f32 v56, v56, v62, v62
    v_fma_f32 v57, v57, v62, v62
    v_rcp_f32 v56, v56
    v_rcp_f32 v57, v57
    v_mul_f32 v56, v56, v108
    v_mul_f32 v57, v57, v109
    v_cvt_pk_bf16_f32 v46, v56, v57
    s_add_u32 m0, s86, 13312
    s_add_u32 s80, s83, 35840
    buffer_load_dwordx4 v24, s[20:23], s80 offen lds
    v_mul_f32 v56, v110, v110
    v_mul_f32 v57, v111, v111
    v_fma_f32 v56, v56, v61, v60
    v_fma_f32 v57, v57, v61, v60
    v_mul_f32 v56, v56, v110
    v_mul_f32 v57, v57, v111
    v_exp_f32 v56, v56
    v_exp_f32 v57, v57
    v_fma_f32 v56, v56, v62, v62
    v_fma_f32 v57, v57, v62, v62
    v_rcp_f32 v56, v56
    v_rcp_f32 v57, v57
    v_mul_f32 v56, v56, v110
    v_mul_f32 v57, v57, v111
    v_cvt_pk_bf16_f32 v47, v56, v57
    s_add_u32 s80, s91, 2048
    buffer_store_dwordx4 v[44:47], v1, s[16:19], s80 offen offset:1024 sc1
    s_waitcnt vmcnt(3)
    s_mov_b64 exec, 1
    v_mov_b32 v4, 159804
    v_mov_b32 v5, 1
    ds_add_rtn_u32 v5, v4, v5
    s_lshl_b32 s80, s70, 3
    s_add_u32 s80, s80, s71
    s_lshl_b32 s80, s80, 7
    s_add_u32 s80, s80, 393216
    s_waitcnt lgkmcnt(0)
    v_readfirstlane_b32 s81, v5
    s_cmp_lg_u32 s81, 3
    s_cbranch_scc1 L_sg_35
    s_mov_b64 exec, 255
    v_mov_b32 v4, s66
    v_mov_b32 v5, s67
    v_mov_b32 v6, s75
    buffer_store_dwordx4 v[4:7], v1, s[16:19], s80 offen sc1
L_sg_35:
    s_mov_b64 exec, -1
    s_nop 0
    v_mul_f32 v56, v112, v112
    v_mul_f32 v57, v113, v113
    v_fma_f32 v56, v56, v37, v36
    v_fma_f32 v57, v57, v37, v36
    v_mul_f32 v56, v56, v112
    v_mul_f32 v57, v57, v113
    v_exp_f32 v56, v56
    v_exp_f32 v57, v57
    v_fma_f32 v56, v56, v38, v38
    v_fma_f32 v57, v57, v38, v38
    v_rcp_f32 v56, v56
    v_rcp_f32 v57, v57
    v_mul_f32 v56, v56, v112
    v_mul_f32 v57, v57, v113
    v_cvt_pk_bf16_f32 v48, v56, v57
    v_mul_f32 v56, v114, v114
    v_mul_f32 v57, v115, v115
    v_fma_f32 v56, v56, v37, v36
    v_fma_f32 v57, v57, v37, v36
    v_mul_f32 v56, v56, v114
    v_mul_f32 v57, v57, v115
    v_exp_f32 v56, v56
    v_exp_f32 v57, v57
    v_fma_f32 v56, v56, v38, v38
    v_fma_f32 v57, v57, v38, v38
    v_rcp_f32 v56, v56
    v_rcp_f32 v57, v57
    v_mul_f32 v56, v56, v114
    v_mul_f32 v57, v57, v115
    v_cvt_pk_bf16_f32 v49, v56, v57
    v_mul_f32 v56, v116, v116
    v_mul_f32 v57, v117, v117
    v_fma_f32 v56, v56, v37, v36
    v_fma_f32 v57, v57, v37, v36
    v_mul_f32 v56, v56, v116
    v_mul_f32 v57, v57, v117
    v_exp_f32 v56, v56
    v_exp_f32 v57, v57
    v_fma_f32 v56, v56, v38, v38
    v_fma_f32 v57, v57, v38, v38
    v_rcp_f32 v56, v56
    v_rcp_f32 v57, v57
    v_mul_f32 v56, v56, v116
    v_mul_f32 v57, v57, v117
    v_cvt_pk_bf16_f32 v50, v56, v57
    v_mul_f32 v56, v118, v118
    v_mul_f32 v57, v119, v119
    v_fma_f32 v56, v56, v37, v36
    v_fma_f32 v57, v57, v37, v36
    v_mul_f32 v56, v56, v118
    v_mul_f32 v57, v57, v119
    v_exp_f32 v56, v56
    v_exp_f32 v57, v57
    v_fma_f32 v56, v56, v38, v38
    v_fma_f32 v57, v57, v38, v38
    v_rcp_f32 v56, v56
    v_rcp_f32 v57, v57
    v_mul_f32 v56, v56, v118
    v_mul_f32 v57, v57, v119
    v_cvt_pk_bf16_f32 v51, v56, v57
    s_add_u32 s80, s91, 116736
    buffer_store_dwordx4 v[48:51], v1, s[16:19], s80 offen offset:0 sc1
    v_mul_f32 v56, v120, v120
    v_mul_f32 v57, v121, v121
    v_fma_f32 v56, v56, v37, v36
    v_fma_f32 v57, v57, v37, v36
    v_mul_f32 v56, v56, v120
    v_mul_f32 v57, v57, v121
    v_exp_f32 v56, v56
    v_exp_f32 v57, v57
    v_fma_f32 v56, v56, v38, v38
    v_fma_f32 v57, v57, v38, v38
    v_rcp_f32 v56, v56
    v_rcp_f32 v57, v57
    v_mul_f32 v56, v56, v120
    v_mul_f32 v57, v57, v121
    v_cvt_pk_bf16_f32 v52, v56, v57
    v_mul_f32 v56, v122, v122
    v_mul_f32 v57, v123, v123
    v_fma_f32 v56, v56, v37, v36
    v_fma_f32 v57, v57, v37, v36
    v_mul_f32 v56, v56, v122
    v_mul_f32 v57, v57, v123
    v_exp_f32 v56, v56
    v_exp_f32 v57, v57
    v_fma_f32 v56, v56, v38, v38
    v_fma_f32 v57, v57, v38, v38
    v_rcp_f32 v56, v56
    v_rcp_f32 v57, v57
    v_mul_f32 v56, v56, v122
    v_mul_f32 v57, v57, v123
    v_cvt_pk_bf16_f32 v53, v56, v57
    v_mul_f32 v56, v124, v124
    v_mul_f32 v57, v125, v125
    v_fma_f32 v56, v56, v37, v36
    v_fma_f32 v57, v57, v37, v36
    v_mul_f32 v56, v56, v124
    v_mul_f32 v57, v57, v125
    v_exp_f32 v56, v56
    v_exp_f32 v57, v57
    v_fma_f32 v56, v56, v38, v38
    v_fma_f32 v57, v57, v38, v38
    v_rcp_f32 v56, v56
    v_rcp_f32 v57, v57
    v_mul_f32 v56, v56, v124
    v_mul_f32 v57, v57, v125
    v_cvt_pk_bf16_f32 v54, v56, v57
    v_mul_f32 v56, v126, v126
    v_mul_f32 v57, v127, v127
    v_fma_f32 v56, v56, v37, v36
    v_fma_f32 v57, v57, v37, v36
    v_mul_f32 v56, v56, v126
    v_mul_f32 v57, v57, v127
    v_exp_f32 v56, v56
    v_exp_f32 v57, v57
    v_fma_f32 v56, v56, v38, v38
    v_fma_f32 v57, v57, v38, v38
    v_rcp_f32 v56, v56
    v_rcp_f32 v57, v57
    v_mul_f32 v56, v56, v126
    v_mul_f32 v57, v57, v127
    v_cvt_pk_bf16_f32 v55, v56, v57
    s_add_u32 s80, s91, 116736
    buffer_store_dwordx4 v[52:55], v1, s[16:19], s80 offen offset:1024 sc1
    ds_read_b64_tr_b16 a[88:89], v25 offset:0
    ds_read_b64_tr_b16 a[90:91], v25 offset:1024
    ds_read_b64_tr_b16 a[92:93], v31 offset:0
    ds_read_b64_tr_b16 a[94:95], v31 offset:1024
    s_waitcnt lgkmcnt(0)
    s_add_u32 m0, s87, 0
    s_add_u32 s80, s83, 43008
    buffer_load_dwordx4 v24, s[20:23], s80 offen lds
    s_add_u32 m0, s87, 1024
    s_add_u32 s80, s83, 50176
    buffer_load_dwordx4 v24, s[20:23], s80 offen lds
    s_mul_i32 s80, s74, 4
    s_add_u32 s80, s80, s69
    s_mul_i32 s80, s80, 28672
    v_add_u32 v26, s80, v1
    s_xor_b32 s80, s74, 1
    s_mul_i32 s80, s80, 4
    s_add_u32 s80, s80, s69
    s_mul_i32 s80, s80, 28672
    v_add_u32 v27, s80, v1
    v_lshlrev_b32 v64, 16, v16
    v_and_b32 v65, 0xffff0000, v16
    v_lshlrev_b32 v66, 16, v17
    v_and_b32 v67, 0xffff0000, v17
    v_lshlrev_b32 v68, 16, v18
    v_and_b32 v69, 0xffff0000, v18
    v_lshlrev_b32 v70, 16, v19
    v_and_b32 v71, 0xffff0000, v19
    v_lshlrev_b32 v72, 16, v20
    v_and_b32 v73, 0xffff0000, v20
    v_lshlrev_b32 v74, 16, v21
    v_and_b32 v75, 0xffff0000, v21
    v_lshlrev_b32 v76, 16, v22
    v_and_b32 v77, 0xffff0000, v22
    v_lshlrev_b32 v78, 16, v23
    v_and_b32 v79, 0xffff0000, v23
    s_lshl_b32 s80, s70, 10
    s_add_u32 s80, s80, 393216
    v_lshlrev_b32 v5, 7, v0
    v_add_u32 v5, s80, v5
    s_mov_b32 s78, 4294967041
    s_mov_b32 s79, -1
    s_mov_b64 vcc, s[78:79]
    v_mov_b32 v7, 2147418112
    v_cndmask_b32 v6, v5, v7, vcc
    v_mov_b32 v36, v6
    buffer_load_dwordx2 v[34:35], v36, s[16:19], 0 offen sc1
    s_lshl_b32 s80, s74, 2
    s_add_u32 s80, s80, 0
    s_lshl_b32 s80, s80, 13
    v_add_u32 v28, s80, v1
    v_xor_b32 v29, 0x8000, v28
    v_and_b32 v32, 31, v0
    s_lshl_b32 s80, s74, 5
    v_add_u32 v32, s80, v32
    v_mul_u32_u24 v32, 896, v32
    v_lshrrev_b32 v33, 5, v0
    v_lshl_add_u32 v32, v33, 4, v32
    s_lshl_b32 s80, s84, 6
    v_add_u32 v30, s80, v32
    s_waitcnt vmcnt(3)
    s_mov_b64 exec, 1
    v_mov_b32 v4, 159808
    v_mov_b32 v5, 1
    ds_add_rtn_u32 v5, v4, v5
    s_lshl_b32 s80, s70, 3
    s_add_u32 s80, s80, s71
    s_lshl_b32 s80, s80, 7
    s_add_u32 s80, s80, 458752
    s_waitcnt lgkmcnt(0)
    v_readfirstlane_b32 s81, v5
    s_cmp_lg_u32 s81, 3
    s_cbranch_scc1 L_sg_36
    s_mov_b64 exec, 255
    v_mov_b32 v4, s66
    v_mov_b32 v5, s67
    v_mov_b32 v6, s75
    buffer_store_dwordx4 v[4:7], v1, s[16:19], s80 offen sc1
L_sg_36:
    s_mov_b64 exec, -1
    s_nop 0
    s_waitcnt vmcnt(0)
    s_mov_b32 s90, 20000
L_ps_37:
    v_cmp_eq_u64 vcc, s[66:67], v[34:35]
    s_or_b64 vcc, vcc, s[78:79]
    s_cmp_eq_u64 vcc, -1
    s_cbranch_scc1 L_pk_38
    s_sub_u32 s90, s90, 1
    s_cbranch_scc1 L_pk_38
    buffer_load_dwordx2 v[34:35], v36, s[16:19], 0 offen sc1
    s_waitcnt vmcnt(0)
    s_branch L_ps_37
L_pk_38:
    s_mul_i32 s97, s93, 4096
    s_add_u32 s92, s97, 5242880
    buffer_load_dwordx4 v[32:35], v26, s[16:19], s92 offen offset:0 sc1
    buffer_load_dwordx4 v[36:39], v27, s[16:19], s92 offen offset:0 sc1
    buffer_load_dwordx4 v[40:43], v26, s[16:19], s92 offen offset:1024 sc1
    buffer_load_dwordx4 v[44:47], v27, s[16:19], s92 offen offset:1024 sc1
    s_add_u32 s97, s97, 4096
    s_cmp_ge_u32 s97, 28672
    s_cselect_b32 s80, 28672, 0
    s_sub_u32 s97, s97, s80
    s_add_u32 s92, s97, 5242880
    buffer_load_dwordx4 v[48:51], v26, s[16:19], s92 offen offset:0 sc1
    buffer_load_dwordx4 v[52:55], v27, s[16:19], s92 offen offset:0 sc1
    buffer_load_dwordx4 v[56:59], v26, s[16:19], s92 offen offset:1024 sc1
    buffer_load_dwordx4 v[60:63], v27, s[16:19], s92 offen offset:1024 sc1
    s_add_u32 s97, s97, 4096
    s_cmp_ge_u32 s97, 28672
    s_cselect_b32 s80, 28672, 0
    s_sub_u32 s97, s97, s80
    s_add_u32 s92, s97, 5242880
    buffer_load_dwordx4 v[16:19], v26, s[16:19], s92 offen offset:0 sc1
    buffer_load_dwordx4 v[20:23], v27, s[16:19], s92 offen offset:0 sc1
    s_waitcnt vmcnt(8)
    v_mfma_f32_32x32x16_bf16 v[64:79], a[96:99], v[32:35], v[64:79]
    v_mfma_f32_32x32x16_bf16 v[96:111], a[100:103], v[32:35], 0
    buffer_load_dwordx4 v[32:35], v26, s[16:19], s92 offen offset:1024 sc1
    v_mfma_f32_32x32x16_bf16 v[80:95], a[96:99], v[36:39], 0
    v_mfma_f32_32x32x16_bf16 v[112:127], a[100:103], v[36:39], 0
    buffer_load_dwordx4 v[36:39], v27, s[16:19], s92 offen offset:1024 sc1
    s_waitcnt vmcnt(8)
    v_mfma_f32_32x32x16_bf16 v[64:79], a[104:107], v[40:43], v[64:79]
    v_mfma_f32_32x32x16_bf16 v[96:111], a[108:111], v[40:43], v[96:111]
    s_add_u32 s97, s97, 4096
    s_cmp_ge_u32 s97, 28672
    s_cselect_b32 s80, 28672, 0
    s_sub_u32 s97, s97, s80
    s_add_u32 s92, s97, 5242880
    buffer_load_dwordx4 v[40:43], v26, s[16:19], s92 offen offset:0 sc1
    ds_read_b64_tr_b16 a[96:97], v25 offset:2048
    ds_read_b64_tr_b16 a[98:99], v25 offset:3072
    v_mfma_f32_32x32x16_bf16 v[80:95], a[104:107], v[44:47], v[80:95]
    v_mfma_f32_32x32x16_bf16 v[112:127], a[108:111], v[44:47], v[112:127]
    buffer_load_dwordx4 v[44:47], v27, s[16:19], s92 offen offset:0 sc1
    ds_read_b64_tr_b16 a[100:101], v31 offset:2048
    ds_read_b64_tr_b16 a[102:103], v31 offset:3072
    s_waitcnt vmcnt(8)
    v_mfma_f32_32x32x16_bf16 v[64:79], a[112:115], v[48:51], v[64:79]
    s_waitcnt lgkmcnt(0)
    s_add_u32 m0, s87, 2048
    s_add_u32 s80, s88, 0
    buffer_load_dwordx4 v24, s[24:27], s80 offen lds
    v_mfma_f32_32x32x16_bf16 v[96:111], a[116:119], v[48:51], v[96:111]
    buffer_load_dwordx4 v[48:51], v26, s[16:19], s92 offen offset:1024 sc1
    ds_read_b64_tr_b16 a[104:105], v25 offset:4096
    ds_read_b64_tr_b16 a[106:107], v25 offset:5120
    v_mfma_f32_32x32x16_bf16 v[80:95], a[112:115], v[52:55], v[80:95]
    s_add_u32 m0, s87, 3072
    s_add_u32 s80, s88, 7168
    buffer_load_dwordx4 v24, s[24:27], s80 offen lds
    v_mfma_f32_32x32x16_bf16 v[112:127], a[116:119], v[52:55], v[112:127]
    buffer_load_dwordx4 v[52:55], v27, s[16:19], s92 offen offset:1024 sc1
    ds_read_b64_tr_b16 a[108:109], v31 offset:4096
    ds_read_b64_tr_b16 a[110:111], v31 offset:5120
    s_waitcnt vmcnt(10)
    v_mfma_f32_32x32x16_bf16 v[64:79], a[120:123], v[56:59], v[64:79]
    s_waitcnt lgkmcnt(0)
    s_add_u32 m0, s87, 4096
    s_add_u32 s80, s88, 14336
    buffer_load_dwordx4 v24, s[24:27], s80 offen lds
    v_mfma_f32_32x32x16_bf16 v[96:111], a[124:127], v[56:59], v[96:111]
    s_add_u32 s97, s97, 4096
    s_cmp_ge_u32 s97, 28672
    s_cselect_b32 s80, 28672, 0
    s_sub_u32 s97, s97, s80
    s_add_u32 s92, s97, 5242880
    buffer_load_dwordx4 v[56:59], v26, s[16:19], s92 offen offset:0 sc1
    ds_read_b64_tr_b16 a[112:113], v25 offset:6144
    ds_read_b64_tr_b16 a[114:115], v25 offset:7168
    v_mfma_f32_32x32x16_bf16 v[80:95], a[120:123], v[60:63], v[80:95]
    s_add_u32 m0, s87, 5120
    s_add_u32 s80, s88, 21504
    buffer_load_dwordx4 v24, s[24:27], s80 offen lds
    v_mfma_f32_32x32x16_bf16 v[112:127], a[124:127], v[60:63], v[112:127]
    buffer_load_dwordx4 v[60:63], v27, s[16:19], s92 offen offset:0 sc1
    ds_read_b64_tr_b16 a[116:117], v31 offset:6144
    ds_read_b64_tr_b16 a[118:119], v31 offset:7168
    s_waitcnt vmcnt(12)
    v_mfma_f32_32x32x16_bf16 v[64:79], a[0:3], v[16:19], v[64:79]
    s_waitcnt lgkmcnt(0)
    s_add_u32 m0, s87, 6144
    s_add_u32 s80, s88, 25088
    buffer_load_dwordx4 v24, s[24:27], s80 offen lds
    v_mfma_f32_32x32x16_bf16 v[96:111], a[4:7], v[16:19], v[96:111]
    buffer_load_dwordx4 v[16:19], v26, s[16:19], s92 offen offset:1024 sc1
    ds_read_b64_tr_b16 a[120:121], v25 offset:8192
    ds_read_b64_tr_b16 a[122:123], v25 offset:9216
    v_mfma_f32_32x32x16_bf16 v[80:95], a[0:3], v[20:23], v[80:95]
    s_add_u32 m0, s87, 7168
    s_add_u32 s80, s88, 32256
    buffer_load_dwordx4 v24, s[24:27], s80 offen lds
    v_mfma_f32_32x32x16_bf16 v[112:127], a[4:7], v[20:23], v[112:127]
    buffer_load_dwordx4 v[20:23], v27, s[16:19], s92 offen offset:1024 sc1
    ds_read_b64_tr_b16 a[124:125], v31 offset:8192
    ds_read_b64_tr_b16 a[126:127], v31 offset:9216
    s_waitcnt vmcnt(14)
    v_mfma_f32_32x32x16_bf16 v[64:79], a[8:11], v[32:35], v[64:79]
    s_waitcnt lgkmcnt(0)
    s_add_u32 m0, s87, 8192
    s_add_u32 s80, s88, 39424
    buffer_load_dwordx4 v24, s[24:27], s80 offen lds
    v_mfma_f32_32x32x16_bf16 v[96:111], a[12:15], v[32:35], v[96:111]
    s_add_u32 s97, s97, 4096
    s_cmp_ge_u32 s97, 28672
    s_cselect_b32 s80, 28672, 0
    s_sub_u32 s97, s97, s80
    s_add_u32 s92, s97, 5242880
    buffer_load_dwordx4 v[32:35], v26, s[16:19], s92 offen offset:0 sc1
    ds_read_b64_tr_b16 a[0:1], v2 offset:0
    ds_read_b64_tr_b16 a[2:3], v2 offset:1024
    v_mfma_f32_32x32x16_bf16 v[80:95], a[8:11], v[36:39], v[80:95]
    s_add_u32 m0, s87, 9216
    s_add_u32 s80, s88, 46592
    buffer_load_dwordx4 v24, s[24:27], s80 offen lds
    v_mfma_f32_32x32x16_bf16 v[112:127], a[12:15], v[36:39], v[112:127]
    buffer_load_dwordx4 v[36:39], v27, s[16:19], s92 offen offset:0 sc1
    ds_read_b64_tr_b16 a[4:5], v3 offset:0
    ds_read_b64_tr_b16 a[6:7], v3 offset:1024
    s_waitcnt vmcnt(16)
    v_mfma_f32_32x32x16_bf16 v[64:79], a[16:19], v[40:43], v[64:79]
    s_waitcnt lgkmcnt(0)
    s_add_u32 m0, s86, 0
    s_add_u32 s80, s88, 50176
    buffer_load_dwordx4 v24, s[24:27], s80 offen lds
    v_mfma_f32_32x32x16_bf16 v[96:111], a[20:23], v[40:43], v[96:111]
    buffer_load_dwordx4 v[40:43], v26, s[16:19], s92 offen offset:1024 sc1
    ds_read_b64_tr_b16 a[8:9], v2 offset:2048
    ds_read_b64_tr_b16 a[10:11], v2 offset:3072
    v_mfma_f32_32x32x16_bf16 v[80:95], a[16:19], v[44:47], v[80:95]
    s_add_u32 m0, s86, 1024
    s_add_u32 s80, s88, 57344
    buffer_load_dwordx4 v24, s[24:27], s80 offen lds
    v_mfma_f32_32x32x16_bf16 v[112:127], a[20:23], v[44:47], v[112:127]
    buffer_load_dwordx4 v[44:47], v27, s[16:19], s92 offen offset:1024 sc1
    ds_read_b64_tr_b16 a[12:13], v3 offset:2048
    ds_read_b64_tr_b16 a[14:15], v3 offset:3072
    s_lshl_b32 s80, s70, 10
    s_add_u32 s80, s80, 458752
    v_lshlrev_b32 v5, 7, v0
    v_add_u32 v5, s80, v5
    s_mov_b32 s78, 4294967041
    s_mov_b32 s79, -1
    s_mov_b64 vcc, s[78:79]
    v_mov_b32 v7, 2147418112
    v_cndmask_b32 v6, v5, v7, vcc
    buffer_load_dwordx2 v[4:5], v6, s[16:19], 0 offen sc1
    s_waitcnt vmcnt(17)
    v_mfma_f32_32x32x16_bf16 v[64:79], a[24:27], v[48:51], v[64:79]
    s_waitcnt lgkmcnt(0)
    s_add_u32 m0, s86, 2048
    s_add_u32 s80, s88, 64512
    buffer_load_dwordx4 v24, s[24:27], s80 offen lds
    v_mfma_f32_32x32x16_bf16 v[96:111], a[28:31], v[48:51], v[96:111]
    s_add_u32 s97, s97, 4096
    s_cmp_ge_u32 s97, 28672
    s_cselect_b32 s80, 28672, 0
    s_sub_u32 s97, s97, s80
    s_add_u32 s92, s97, 5242880
    buffer_load_dwordx4 v[48:51], v26, s[16:19], s92 offen offset:0 sc1
    ds_read_b64_tr_b16 a[16:17], v2 offset:4096
    ds_read_b64_tr_b16 a[18:19], v2 offset:5120
    v_mfma_f32_32x32x16_bf16 v[80:95], a[24:27], v[52:55], v[80:95]
    s_add_u32 m0, s86, 3072
    s_add_u32 s80, s88, 71680
    buffer_load_dwordx4 v24, s[24:27], s80 offen lds
    v_mfma_f32_32x32x16_bf16 v[112:127], a[28:31], v[52:55], v[112:127]
    buffer_load_dwordx4 v[52:55], v27, s[16:19], s92 offen offset:0 sc1
    ds_read_b64_tr_b16 a[20:21], v3 offset:4096
    ds_read_b64_tr_b16 a[22:23], v3 offset:5120
    s_waitcnt vmcnt(17)
    v_mfma_f32_32x32x16_bf16 v[64:79], a[32:35], v[56:59], v[64:79]
    s_waitcnt lgkmcnt(0)
    s_add_u32 m0, s86, 4096
    s_add_u32 s80, s88, 75264
    buffer_load_dwordx4 v24, s[24:27], s80 offen lds
    v_mfma_f32_32x32x16_bf16 v[96:111], a[36:39], v[56:59], v[96:111]
    buffer_load_dwordx4 v[56:59], v26, s[16:19], s92 offen offset:1024 sc1
    ds_read_b64_tr_b16 a[24:25], v2 offset:6144
    ds_read_b64_tr_b16 a[26:27], v2 offset:7168
    v_mfma_f32_32x32x16_bf16 v[80:95], a[32:35], v[60:63], v[80:95]
    s_add_u32 m0, s86, 5120
    s_add_u32 s80, s88, 82432
    buffer_load_dwordx4 v24, s[24:27], s80 offen lds
    v_mfma_f32_32x32x16_bf16 v[112:127], a[36:39], v[60:63], v[112:127]
    buffer_load_dwordx4 v[60:63], v27, s[16:19], s92 offen offset:1024 sc1
    ds_read_b64_tr_b16 a[28:29], v3 offset:6144
    ds_read_b64_tr_b16 a[30:31], v3 offset:7168
    s_waitcnt vmcnt(17)
    s_waitcnt vmcnt(8)
    s_mov_b32 s90, 20000
L_ps_39:
    v_cmp_eq_u64 vcc, s[66:67], v[4:5]
    s_or_b64 vcc, vcc, s[78:79]
    s_cmp_eq_u64 vcc, -1
    s_cbranch_scc1 L_pk_40
    s_sub_u32 s90, s90, 1
    s_cbranch_scc1 L_pk_40
    buffer_load_dwordx2 v[4:5], v6, s[16:19], 0 offen sc1
    s_waitcnt vmcnt(0)
    s_branch L_ps_39
L_pk_40:
    v_mfma_f32_32x32x16_bf16 v[64:79], a[40:43], v[16:19], v[64:79]
    s_waitcnt lgkmcnt(0)
    s_add_u32 m0, s86, 6144
    s_add_u32 s80, s88, 89600
    buffer_load_dwordx4 v24, s[24:27], s80 offen lds
    v_mfma_f32_32x32x16_bf16 v[96:111], a[44:47], v[16:19], v[96:111]
    s_mul_i32 s97, s93, 4096
    s_add_u32 s92, s97, 5242880
    buffer_load_dwordx4 v[16:19], v26, s[16:19], s92 offen offset:2048 sc1
    ds_read_b64_tr_b16 a[32:33], v2 offset:8192
    ds_read_b64_tr_b16 a[34:35], v2 offset:9216
    v_mfma_f32_32x32x16_bf16 v[80:95], a[40:43], v[20:23], v[80:95]
    s_add_u32 m0, s86, 7168
    s_add_u32 s80, s88, 96768
    buffer_load_dwordx4 v24, s[24:27], s80 offen lds
    v_mfma_f32_32x32x16_bf16 v[112:127], a[44:47], v[20:23], v[112:127]
    buffer_load_dwordx4 v[20:23], v27, s[16:19], s92 offen offset:2048 sc1
    ds_read_b64_tr_b16 a[36:37], v3 offset:8192
    ds_read_b64_tr_b16 a[38:39], v3 offset:9216
    v_mfma_f32_32x32x16_bf16 v[64:79], a[48:51], v[32:35], v[64:79]
    v_mfma_f32_32x32x16_bf16 v[96:111], a[52:55], v[32:35], v[96:111]
    buffer_load_dwordx4 v[32:35], v26, s[16:19], s92 offen offset:3072 sc1
    ds_read_b64_tr_b16 a[40:41], v2 offset:10240
    ds_read_b64_tr_b16 a[42:43], v2 offset:11264
    v_mfma_f32_32x32x16_bf16 v[80:95], a[48:51], v[36:39], v[80:95]
    v_mfma_f32_32x32x16_bf16 v[112:127], a[52:55], v[36:39], v[112:127]
    buffer_load_dwordx4 v[36:39], v27, s[16:19], s92 offen offset:3072 sc1
    ds_read_b64_tr_b16 a[44:45], v3 offset:10240
    ds_read_b64_tr_b16 a[46:47], v3 offset:11264
    v_mfma_f32_32x32x16_bf16 v[64:79], a[56:59], v[40:43], v[64:79]
    v_mfma_f32_32x32x16_bf16 v[96:111], a[60:63], v[40:43], v[96:111]
    s_add_u32 s97, s97, 4096
    s_cmp_ge_u32 s97, 28672
    s_cselect_b32 s80, 28672, 0
    s_sub_u32 s97, s97, s80
    s_add_u32 s92, s97, 5242880
    buffer_load_dwordx4 v[40:43], v26, s[16:19], s92 offen offset:2048 sc1
    ds_read_b64_tr_b16 a[48:49], v2 offset:12288
    ds_read_b64_tr_b16 a[50:51], v2 offset:13312
    v_mfma_f32_32x32x16_bf16 v[80:95], a[56:59], v[44:47], v[80:95]
    v_mfma_f32_32x32x16_bf16 v[112:127], a[60:63], v[44:47], v[112:127]
    buffer_load_dwordx4 v[44:47], v27, s[16:19], s92 offen offset:2048 sc1
    ds_read_b64_tr_b16 a[52:53], v3 offset:12288
    ds_read_b64_tr_b16 a[54:55], v3 offset:13312
    s_waitcnt vmcnt(12)
    v_mfma_f32_32x32x16_bf16 v[64:79], a[64:67], v[48:51], v[64:79]
    v_mfma_f32_32x32x16_bf16 v[96:111], a[68:71], v[48:51], v[96:111]
    buffer_load_dwordx4 v[48:51], v26, s[16:19], s92 offen offset:3072 sc1
    ds_read_b64_tr_b16 a[56:57], v25 offset:0
    ds_read_b64_tr_b16 a[58:59], v25 offset:1024
    v_mfma_f32_32x32x16_bf16 v[80:95], a[64:67], v[52:55], v[80:95]
    v_mfma_f32_32x32x16_bf16 v[112:127], a[68:71], v[52:55], v[112:127]
    buffer_load_dwordx4 v[52:55], v27, s[16:19], s92 offen offset:3072 sc1
    ds_read_b64_tr_b16 a[60:61], v31 offset:0
    ds_read_b64_tr_b16 a[62:63], v31 offset:1024
    s_waitcnt vmcnt(10)
    v_mfma_f32_32x32x16_bf16 v[64:79], a[72:75], v[56:59], v[64:79]
    v_mfma_f32_32x32x16_bf16 v[96:111], a[76:79], v[56:59], v[96:111]
    s_add_u32 s97, s97, 4096
    s_cmp_ge_u32 s97, 28672
    s_cselect_b32 s80, 28672, 0
    s_sub_u32 s97, s97, s80
    s_add_u32 s92, s97, 5242880
    buffer_load_dwordx4 v[56:59], v26, s[16:19], s92 offen offset:2048 sc1
    v_mfma_f32_32x32x16_bf16 v[80:95], a[72:75], v[60:63], v[80:95]
    v_mfma_f32_32x32x16_bf16 v[112:127], a[76:79], v[60:63], v[112:127]
    buffer_load_dwordx4 v[60:63], v27, s[16:19], s92 offen offset:2048 sc1
    s_waitcnt vmcnt(8)
    v_mfma_f32_32x32x16_bf16 v[64:79], a[80:83], v[16:19], v[64:79]
    v_mfma_f32_32x32x16_bf16 v[96:111], a[84:87], v[16:19], v[96:111]
    buffer_load_dwordx4 v[16:19], v26, s[16:19], s92 offen offset:3072 sc1
    v_mfma_f32_32x32x16_bf16 v[80:95], a[80:83], v[20:23], v[80:95]
    v_mfma_f32_32x32x16_bf16 v[112:127], a[84:87], v[20:23], v[112:127]
    buffer_load_dwordx4 v[20:23], v27, s[16:19], s92 offen offset:3072 sc1
    s_waitcnt lgkmcnt(0)
    s_mov_b64 exec, 1
    v_mov_b32 v4, 159792
    v_mov_b32 v5, 1
    ds_add_u32 v4, v5
    s_mov_b64 exec, -1
    s_waitcnt vmcnt(8)
    v_mfma_f32_32x32x16_bf16 v[64:79], a[88:91], v[32:35], v[64:79]
    v_mfma_f32_32x32x16_bf16 v[96:111], a[92:95], v[32:35], v[96:111]
    s_add_u32 s97, s97, 4096
    s_cmp_ge_u32 s97, 28672
    s_cselect_b32 s80, 28672, 0
    s_sub_u32 s97, s97, s80
    s_add_u32 s92, s97, 5242880
    buffer_load_dwordx4 v[32:35], v26, s[16:19], s92 offen offset:2048 sc1
    v_mfma_f32_32x32x16_bf16 v[80:95], a[88:91], v[36:39], v[80:95]
    v_mfma_f32_32x32x16_bf16 v[112:127], a[92:95], v[36:39], v[112:127]
    buffer_load_dwordx4 v[36:39], v27, s[16:19], s92 offen offset:2048 sc1
    s_waitcnt vmcnt(8)
    v_mfma_f32_32x32x16_bf16 v[64:79], a[96:99], v[40:43], v[64:79]
    v_mfma_f32_32x32x16_bf16 v[96:111], a[100:103], v[40:43], v[96:111]
    buffer_load_dwordx4 v[40:43], v26, s[16:19], s92 offen offset:3072 sc1
    v_mfma_f32_32x32x16_bf16 v[80:95], a[96:99], v[44:47], v[80:95]
    v_mfma_f32_32x32x16_bf16 v[112:127], a[100:103], v[44:47], v[112:127]
    buffer_load_dwordx4 v[44:47], v27, s[16:19], s92 offen offset:3072 sc1
    s_waitcnt vmcnt(8)
    v_mfma_f32_32x32x16_bf16 v[64:79], a[104:107], v[48:51], v[64:79]
    v_mfma_f32_32x32x16_bf16 v[96:111], a[108:111], v[48:51], v[96:111]
    s_add_u32 s97, s97, 4096
    s_cmp_ge_u32 s97, 28672
    s_cselect_b32 s80, 28672, 0
    s_sub_u32 s97, s97, s80
    s_add_u32 s92, s97, 5242880
    buffer_load_dwordx4 v[48:51], v26, s[16:19], s92 offen offset:2048 sc1
    v_mfma_f32_32x32x16_bf16 v[80:95], a[104:107], v[52:55], v[80:95]
    v_mfma_f32_32x32x16_bf16 v[112:127], a[108:111], v[52:55], v[112:127]
    buffer_load_dwordx4 v[52:55], v27, s[16:19], s92 offen offset:2048 sc1
    s_waitcnt vmcnt(8)
    v_mfma_f32_32x32x16_bf16 v[64:79], a[112:115], v[56:59], v[64:79]
    v_mfma_f32_32x32x16_bf16 v[96:111], a[116:119], v[56:59], v[96:111]
    buffer_load_dwordx4 v[56:59], v26, s[16:19], s92 offen offset:3072 sc1
    v_mfma_f32_32x32x16_bf16 v[80:95], a[112:115], v[60:63], v[80:95]
    v_mfma_f32_32x32x16_bf16 v[112:127], a[116:119], v[60:63], v[112:127]
    buffer_load_dwordx4 v[60:63], v27, s[16:19], s92 offen offset:3072 sc1
    s_waitcnt vmcnt(8)
    v_mfma_f32_32x32x16_bf16 v[64:79], a[120:123], v[16:19], v[64:79]
    v_mfma_f32_32x32x16_bf16 v[96:111], a[124:127], v[16:19], v[96:111]
    s_add_u32 s97, s97, 4096
    s_cmp_ge_u32 s97, 28672
    s_cselect_b32 s80, 28672, 0
    s_sub_u32 s97, s97, s80
    s_add_u32 s92, s97, 5242880
    buffer_load_dwordx4 v[16:19], v26, s[16:19], s92 offen offset:2048 sc1
    v_mfma_f32_32x32x16_bf16 v[80:95], a[120:123], v[20:23], v[80:95]
    v_mfma_f32_32x32x16_bf16 v[112:127], a[124:127], v[20:23], v[112:127]
    buffer_load_dwordx4 v[20:23], v27, s[16:19], s92 offen offset:2048 sc1
    s_waitcnt vmcnt(8)
    v_mfma_f32_32x32x16_bf16 v[64:79], a[0:3], v[32:35], v[64:79]
    v_mfma_f32_32x32x16_bf16 v[96:111], a[4:7], v[32:35], v[96:111]
    buffer_load_dwordx4 v[32:35], v26, s[16:19], s92 offen offset:3072 sc1
    v_mfma_f32_32x32x16_bf16 v[80:95], a[0:3], v[36:39], v[80:95]
    v_mfma_f32_32x32x16_bf16 v[112:127], a[4:7], v[36:39], v[112:127]
    buffer_load_dwordx4 v[36:39], v27, s[16:19], s92 offen offset:3072 sc1
    s_waitcnt vmcnt(8)
    v_mfma_f32_32x32x16_bf16 v[64:79], a[8:11], v[40:43], v[64:79]
    v_mfma_f32_32x32x16_bf16 v[96:111], a[12:15], v[40:43], v[96:111]
    s_add_u32 s97, s97, 4096
    s_cmp_ge_u32 s97, 28672
    s_cselect_b32 s80, 28672, 0
    s_sub_u32 s97, s97, s80
    s_add_u32 s92, s97, 5242880
    buffer_load_dwordx4 v[40:43], v26, s[16:19], s92 offen offset:2048 sc1
    v_mfma_f32_32x32x16_bf16 v[80:95], a[8:11], v[44:47], v[80:95]
    v_mfma_f32_32x32x16_bf16 v[112:127], a[12:15], v[44:47], v[112:127]
    buffer_load_dwordx4 v[44:47], v27, s[16:19], s92 offen offset:2048 sc1
    s_waitcnt vmcnt(8)
    v_mfma_f32_32x32x16_bf16 v[64:79], a[16:19], v[48:51], v[64:79]
    v_mfma_f32_32x32x16_bf16 v[96:111], a[20:23], v[48:51], v[96:111]
    buffer_load_dwordx4 v[48:51], v26, s[16:19], s92 offen offset:3072 sc1
    v_mfma_f32_32x32x16_bf16 v[80:95], a[16:19], v[52:55], v[80:95]
    v_mfma_f32_32x32x16_bf16 v[112:127], a[20:23], v[52:55], v[112:127]
    buffer_load_dwordx4 v[52:55], v27, s[16:19], s92 offen offset:3072 sc1
    s_waitcnt vmcnt(8)
    v_mfma_f32_32x32x16_bf16 v[64:79], a[24:27], v[56:59], v[64:79]
    v_mfma_f32_32x32x16_bf16 v[96:111], a[28:31], v[56:59], v[96:111]
    v_mfma_f32_32x32x16_bf16 v[80:95], a[24:27], v[60:63], v[80:95]
    v_mfma_f32_32x32x16_bf16 v[112:127], a[28:31], v[60:63], v[112:127]
    s_xor_b32 s80, s69, 0
    s_mul_i32 s80, s80, 12288
    s_add_u32 s80, s80, 57344
    v_add_u32 v24, s80, v1
    s_xor_b32 s80, s69, 1
    s_mul_i32 s80, s80, 12288
    s_add_u32 s80, s80, 57344
    v_add_u32 v26, s80, v1
    s_xor_b32 s80, s69, 2
    s_mul_i32 s80, s80, 12288
    s_add_u32 s80, s80, 57344
    v_add_u32 v27, s80, v1
    s_xor_b32 s80, s69, 3
    s_mul_i32 s80, s80, 12288
    s_add_u32 s80, s80, 57344
    v_add_u32 v29, s80, v1
    v_add_u32 v28, s86, v1
    s_xor_b32 s80, s69, 2
    s_mul_i32 s81, s80, 14336
    s_mul_i32 s80, s80, 11264
    s_add_u32 s80, s80, 114688
    v_add_u32 v2, s81, v1
    v_add_u32 v3, s80, v1
    v_mov_b32 v4, 159812
    s_mov_b32 s90, 0
L_ls_41:
    ds_read_b32 v5, v4
    s_add_u32 s90, s90, 1
    s_waitcnt lgkmcnt(0)
    v_readfirstlane_b32 s100, v5
    s_cmp_ge_u32 s100, 4
    s_cbranch_scc1 L_lk_42
    s_cmp_lt_u32 s90, 400000
    s_cbranch_scc1 L_ls_41
L_lk_42:
    s_waitcnt vmcnt(7)
    v_mfma_f32_32x32x16_bf16 v[96:111], a[36:39], v[16:19], v[96:111]
    s_waitcnt vmcnt(5)
    v_mfma_f32_32x32x16_bf16 v[96:111], a[44:47], v[32:35], v[96:111]
    s_waitcnt vmcnt(3)
    v_mfma_f32_32x32x16_bf16 v[96:111], a[52:55], v[40:43], v[96:111]
    s_waitcnt vmcnt(1)
    v_mfma_f32_32x32x16_bf16 v[96:111], a[60:63], v[48:51], v[96:111]
    v_mfma_f32_32x32x16_bf16 v[80:95], a[32:35], v[20:23], v[80:95]
    v_mfma_f32_32x32x16_bf16 v[80:95], a[40:43], v[36:39], v[80:95]
    v_mfma_f32_32x32x16_bf16 v[80:95], a[48:51], v[44:47], v[80:95]
    s_waitcnt vmcnt(0)
    v_mfma_f32_32x32x16_bf16 v[80:95], a[56:59], v[52:55], v[80:95]
    s_nop 6
    v_mfma_f32_32x32x16_bf16 v[112:127], a[36:39], v[20:23], v[112:127]
    ds_write_b128 v24, v[96:99] offset:4096
    v_mfma_f32_32x32x16_bf16 v[112:127], a[44:47], v[36:39], v[112:127]
    ds_write_b128 v24, v[100:103] offset:5120
    v_mfma_f32_32x32x16_bf16 v[112:127], a[52:55], v[44:47], v[112:127]
    ds_write_b128 v24, v[104:107] offset:6144
    v_mfma_f32_32x32x16_bf16 v[112:127], a[60:63], v[52:55], v[112:127]
    ds_write_b128 v24, v[108:111] offset:7168
    v_mfma_f32_32x32x16_bf16 v[64:79], a[32:35], v[16:19], v[64:79]
    ds_write_b128 v24, v[80:83] offset:0
    v_mfma_f32_32x32x16_bf16 v[64:79], a[40:43], v[32:35], v[64:79]
    ds_write_b128 v24, v[84:87] offset:1024
    v_mfma_f32_32x32x16_bf16 v[64:79], a[48:51], v[40:43], v[64:79]
    ds_write_b128 v24, v[88:91] offset:2048
    v_mfma_f32_32x32x16_bf16 v[64:79], a[56:59], v[48:51], v[64:79]
    ds_write_b128 v24, v[92:95] offset:3072
    s_nop 3
    ds_write_b128 v24, v[112:115] offset:8192
    ds_write_b128 v24, v[116:119] offset:9216
    ds_write_b128 v24, v[120:123] offset:10240
    ds_write_b128 v24, v[124:127] offset:11264
    s_mov_b64 exec, 1
    v_mov_b32 v4, 159788
    v_mov_b32 v5, 1
    ds_add_u32 v4, v5
    s_mov_b64 exec, -1
    v_mov_b32 v4, 159788
    s_mov_b32 s90, 0
L_ls_43:
    ds_read_b32 v5, v4
    s_add_u32 s90, s90, 1
    s_waitcnt lgkmcnt(0)
    v_readfirstlane_b32 s100, v5
    s_cmp_ge_u32 s100, 4
    s_cbranch_scc1 L_lk_44
    s_cmp_lt_u32 s90, 400000
    s_cbranch_scc1 L_ls_43
L_lk_44:
    ds_read_b128 v[80:83], v26 offset:0
    ds_read_b128 v[84:87], v26 offset:1024
    ds_read_b128 v[88:91], v26 offset:2048
    ds_read_b128 v[92:95], v26 offset:3072
    ds_read_b128 v[96:99], v27 offset:4096
    ds_read_b128 v[100:103], v27 offset:5120
    ds_read_b128 v[104:107], v27 offset:6144
    ds_read_b128 v[108:111], v27 offset:7168
    ds_read_b128 v[112:115], v29 offset:8192
    ds_read_b128 v[116:119], v29 offset:9216
    ds_read_b128 v[120:123], v29 offset:10240
    ds_read_b128 v[124:127], v29 offset:11264
    s_waitcnt lgkmcnt(8)
    v_add_f32 v64, v64, v80
    v_add_f32 v65, v65, v81
    v_add_f32 v66, v66, v82
    v_add_f32 v67, v67, v83
    v_add_f32 v68, v68, v84
    v_add_f32 v69, v69, v85
    v_add_f32 v70, v70, v86
    v_add_f32 v71, v71, v87
    v_add_f32 v72, v72, v88
    v_add_f32 v73, v73, v89
    v_add_f32 v74, v74, v90
    v_add_f32 v75, v75, v91
    v_add_f32 v76, v76, v92
    v_add_f32 v77, v77, v93
    v_add_f32 v78, v78, v94
    v_add_f32 v79, v79, v95
    s_waitcnt lgkmcnt(4)
    v_add_f32 v64, v64, v96
    v_add_f32 v65, v65, v97
    v_add_f32 v66, v66, v98
    v_add_f32 v67, v67, v99
    v_add_f32 v68, v68, v100
    v_add_f32 v69, v69, v101
    v_add_f32 v70, v70, v102
    v_add_f32 v71, v71, v103
    v_add_f32 v72, v72, v104
    v_add_f32 v73, v73, v105
    v_add_f32 v74, v74, v106
    v_add_f32 v75, v75, v107
    v_add_f32 v76, v76, v108
    v_add_f32 v77, v77, v109
    v_add_f32 v78, v78, v110
    v_add_f32 v79, v79, v111
    s_waitcnt lgkmcnt(0)
    v_add_f32 v64, v64, v112
    v_add_f32 v65, v65, v113
    v_add_f32 v66, v66, v114
    v_add_f32 v67, v67, v115
    v_add_f32 v68, v68, v116
    v_add_f32 v69, v69, v117
    v_add_f32 v70, v70, v118
    v_add_f32 v71, v71, v119
    v_add_f32 v72, v72, v120
    v_add_f32 v73, v73, v121
    v_add_f32 v74, v74, v122
    v_add_f32 v75, v75, v123
    v_add_f32 v76, v76, v124
    v_add_f32 v77, v77, v125
    v_add_f32 v78, v78, v126
    v_add_f32 v79, v79, v127
    v_mul_f32 v80, 0xbfb8aa3b, v64
    v_mul_f32 v81, 0xbfb8aa3b, v65
    v_exp_f32 v80, v80
    v_exp_f32 v81, v81
    v_add_f32 v80, 1.0, v80
    v_add_f32 v81, 1.0, v81
    v_rcp_f32 v80, v80
    v_rcp_f32 v81, v81
    v_mul_f32 v64, v64, v80
    v_mul_f32 v65, v65, v81
    v_mul_f32 v80, 0xbfb8aa3b, v66
    v_mul_f32 v81, 0xbfb8aa3b, v67
    v_exp_f32 v80, v80
    v_exp_f32 v81, v81
    v_add_f32 v80, 1.0, v80
    v_add_f32 v81, 1.0, v81
    v_rcp_f32 v80, v80
    v_rcp_f32 v81, v81
    v_mul_f32 v66, v66, v80
    v_mul_f32 v67, v67, v81
    v_mul_f32 v80, 0xbfb8aa3b, v68
    v_mul_f32 v81, 0xbfb8aa3b, v69
    v_exp_f32 v80, v80
    v_exp_f32 v81, v81
    v_add_f32 v80, 1.0, v80
    v_add_f32 v81, 1.0, v81
    v_rcp_f32 v80, v80
    v_rcp_f32 v81, v81
    v_mul_f32 v68, v68, v80
    v_mul_f32 v69, v69, v81
    v_mul_f32 v80, 0xbfb8aa3b, v70
    v_mul_f32 v81, 0xbfb8aa3b, v71
    v_exp_f32 v80, v80
    v_exp_f32 v81, v81
    v_add_f32 v80, 1.0, v80
    v_add_f32 v81, 1.0, v81
    v_rcp_f32 v80, v80
    v_rcp_f32 v81, v81
    v_mul_f32 v70, v70, v80
    v_mul_f32 v71, v71, v81
    v_mul_f32 v80, 0xbfb8aa3b, v72
    v_mul_f32 v81, 0xbfb8aa3b, v73
    v_exp_f32 v80, v80
    v_exp_f32 v81, v81
    v_add_f32 v80, 1.0, v80
    v_add_f32 v81, 1.0, v81
    v_rcp_f32 v80, v80
    v_rcp_f32 v81, v81
    v_mul_f32 v72, v72, v80
    v_mul_f32 v73, v73, v81
    v_mul_f32 v80, 0xbfb8aa3b, v74
    v_mul_f32 v81, 0xbfb8aa3b, v75
    v_exp_f32 v80, v80
    v_exp_f32 v81, v81
    v_add_f32 v80, 1.0, v80
    v_add_f32 v81, 1.0, v81
    v_rcp_f32 v80, v80
    v_rcp_f32 v81, v81
    v_mul_f32 v74, v74, v80
    v_mul_f32 v75, v75, v81
    v_mul_f32 v80, 0xbfb8aa3b, v76
    v_mul_f32 v81, 0xbfb8aa3b, v77
    v_exp_f32 v80, v80
    v_exp_f32 v81, v81
    v_add_f32 v80, 1.0, v80
    v_add_f32 v81, 1.0, v81
    v_rcp_f32 v80, v80
    v_rcp_f32 v81, v81
    v_mul_f32 v76, v76, v80
    v_mul_f32 v77, v77, v81
    v_mul_f32 v80, 0xbfb8aa3b, v78
    v_mul_f32 v81, 0xbfb8aa3b, v79
    v_exp_f32 v80, v80
    v_exp_f32 v81, v81
    v_add_f32 v80, 1.0, v80
    v_add_f32 v81, 1.0, v81
    v_rcp_f32 v80, v80
    v_rcp_f32 v81, v81
    v_mul_f32 v78, v78, v80
    v_mul_f32 v79, v79, v81
    s_lshl_b32 s80, s72, 2
    s_add_u32 s80, s80, 159864
    v_mov_b32 v4, s80
    s_mov_b32 s90, 0
L_ls_45:
    ds_read_b32 v5, v4
    s_add_u32 s90, s90, 1
    s_waitcnt lgkmcnt(0)
    v_readfirstlane_b32 s100, v5
    s_cmp_ge_u32 s100, 2
    s_cbranch_scc1 L_lk_46
    s_cmp_lt_u32 s90, 400000
    s_cbranch_scc1 L_ls_45
L_lk_46:
    ds_read_b128 v[32:35], v28 offset:8192
    ds_read_b128 v[96:99], v2 offset:12288
    ds_read_b128 v[36:39], v28 offset:9216
    ds_read_b128 v[100:103], v2 offset:13312
    ds_read_b128 v[40:43], v28 offset:10240
    ds_read_b128 v[104:107], v3 offset:0
    ds_read_b128 v[44:47], v28 offset:11264
    ds_read_b128 v[108:111], v3 offset:1024
    s_waitcnt lgkmcnt(0)
    v_add_f32 v32, v32, v96
    v_add_f32 v33, v33, v97
    v_add_f32 v34, v34, v98
    v_add_f32 v35, v35, v99
    v_add_f32 v36, v36, v100
    v_add_f32 v37, v37, v101
    v_add_f32 v38, v38, v102
    v_add_f32 v39, v39, v103
    v_add_f32 v40, v40, v104
    v_add_f32 v41, v41, v105
    v_add_f32 v42, v42, v106
    v_add_f32 v43, v43, v107
    v_add_f32 v44, v44, v108
    v_add_f32 v45, v45, v109
    v_add_f32 v46, v46, v110
    v_add_f32 v47, v47, v111
    v_lshlrev_b32 v80, 16, v8
    v_and_b32 v81, 0xffff0000, v8
    v_fma_f32 v80, v32, v64, v80
    v_fma_f32 v81, v33, v65, v81
    v_cvt_pk_bf16_f32 v84, v80, v81
    v_lshlrev_b32 v80, 16, v9
    v_and_b32 v81, 0xffff0000, v9
    v_fma_f32 v80, v34, v66, v80
    v_fma_f32 v81, v35, v67, v81
    v_cvt_pk_bf16_f32 v85, v80, v81
    v_lshlrev_b32 v80, 16, v10
    v_and_b32 v81, 0xffff0000, v10
    v_fma_f32 v80, v36, v68, v80
    v_fma_f32 v81, v37, v69, v81
    v_cvt_pk_bf16_f32 v86, v80, v81
    v_lshlrev_b32 v80, 16, v11
    v_and_b32 v81, 0xffff0000, v11
    v_fma_f32 v80, v38, v70, v80
    v_fma_f32 v81, v39, v71, v81
    v_cvt_pk_bf16_f32 v87, v80, v81
    v_lshlrev_b32 v80, 16, v12
    v_and_b32 v81, 0xffff0000, v12
    v_fma_f32 v80, v40, v72, v80
    v_fma_f32 v81, v41, v73, v81
    v_cvt_pk_bf16_f32 v88, v80, v81
    v_lshlrev_b32 v80, 16, v13
    v_and_b32 v81, 0xffff0000, v13
    v_fma_f32 v80, v42, v74, v80
    v_fma_f32 v81, v43, v75, v81
    v_cvt_pk_bf16_f32 v89, v80, v81
    v_lshlrev_b32 v80, 16, v14
    v_and_b32 v81, 0xffff0000, v14
    v_fma_f32 v80, v44, v76, v80
    v_fma_f32 v81, v45, v77, v81
    v_cvt_pk_bf16_f32 v90, v80, v81
    v_lshlrev_b32 v80, 16, v15
    v_and_b32 v81, 0xffff0000, v15
    v_fma_f32 v80, v46, v78, v80
    v_fma_f32 v81, v47, v79, v81
    v_cvt_pk_bf16_f32 v91, v80, v81
    s_nop 1
    v_permlane32_swap_b32 v84, v86
    v_permlane32_swap_b32 v85, v87
    v_permlane32_swap_b32 v88, v90
    v_permlane32_swap_b32 v89, v91
    buffer_store_dwordx4 v[84:87], v30, s[28:31], 0 offen offset:0
    buffer_store_dwordx4 v[88:91], v30, s[28:31], 0 offen offset:32
    s_endpgm
L_cskv:
    ds_read_b64_tr_b16 a[0:1], v29 offset:0
    ds_read_b64_tr_b16 a[2:3], v29 offset:224
    s_mov_b64 s[36:37], s[54:55]
    ds_read_b64_tr_b16 a[4:5], v29 offset:896
    ds_read_b64_tr_b16 a[6:7], v29 offset:1120
    s_mov_b32 s38, 401408
    s_mov_b32 s39, 0x20000
    ds_read_b64_tr_b16 a[8:9], v29 offset:1792
    ds_read_b64_tr_b16 a[10:11], v29 offset:2016
    s_mov_b64 s[12:13], s[56:57]
    ds_read_b64_tr_b16 a[12:13], v29 offset:2688
    ds_read_b64_tr_b16 a[14:15], v29 offset:2912
    s_mov_b32 s14, 1605632
    s_mov_b32 s15, 0x20000
    ds_read_b64_tr_b16 a[16:17], v29 offset:3584
    ds_read_b64_tr_b16 a[18:19], v29 offset:3808
    s_waitcnt lgkmcnt(8)
    v_mfma_f32_32x32x16_bf16 v[48:63], a[0:3], v[96:99], 0
    s_mov_b64 s[20:21], s[58:59]
    ds_read_b64_tr_b16 a[20:21], v29 offset:4480
    ds_read_b64_tr_b16 a[22:23], v29 offset:4704
    s_waitcnt lgkmcnt(8)
    v_mfma_f32_32x32x16_bf16 v[48:63], a[4:7], v[96:99], v[48:63]
    s_mov_b32 s22, 1605632
    s_mov_b32 s23, 0x20000
    ds_read_b64_tr_b16 a[24:25], v29 offset:5376
    ds_read_b64_tr_b16 a[26:27], v29 offset:5600
    s_waitcnt lgkmcnt(8)
    v_mfma_f32_32x32x16_bf16 v[48:63], a[8:11], v[96:99], v[48:63]
    s_mov_b64 s[24:25], s[48:49]
    s_mov_b32 s26, 401408
    ds_read_b64_tr_b16 a[28:29], v29 offset:6272
    ds_read_b64_tr_b16 a[30:31], v29 offset:6496
    s_waitcnt lgkmcnt(8)
    v_mfma_f32_32x32x16_bf16 v[48:63], a[12:15], v[96:99], v[48:63]
    s_mov_b32 s27, 0x20000
    ds_read_b64_tr_b16 a[32:33], v29 offset:7168
    ds_read_b64_tr_b16 a[34:35], v29 offset:7392
    s_waitcnt lgkmcnt(8)
    v_mfma_f32_32x32x16_bf16 v[48:63], a[16:19], v[96:99], v[48:63]
    s_mov_b64 s[28:29], s[60:61]
    s_mov_b32 s30, 1835008
    ds_read_b64_tr_b16 a[36:37], v29 offset:8064
    ds_read_b64_tr_b16 a[38:39], v29 offset:8288
    s_waitcnt lgkmcnt(8)
    v_mfma_f32_32x32x16_bf16 v[48:63], a[20:23], v[96:99], v[48:63]
    s_mov_b32 s31, 0x20000
    ds_read_b64_tr_b16 a[40:41], v29 offset:8960
    ds_read_b64_tr_b16 a[42:43], v29 offset:9184
    s_waitcnt lgkmcnt(8)
    v_mfma_f32_32x32x16_bf16 v[48:63], a[24:27], v[96:99], v[48:63]
    s_max_u32 s81, s71, 1
    s_sub_u32 s81, s81, 1
    ds_read_b64_tr_b16 a[44:45], v29 offset:9856
    ds_read_b64_tr_b16 a[46:47], v29 offset:10080
    s_waitcnt lgkmcnt(8)
    v_mfma_f32_32x32x16_bf16 v[48:63], a[28:31], v[96:99], v[48:63]
    s_lshl_b32 s84, s81, 1
    s_add_u32 s84, s84, s73
    ds_read_b64_tr_b16 a[48:49], v29 offset:10752
    ds_read_b64_tr_b16 a[50:51], v29 offset:10976
    s_waitcnt lgkmcnt(8)
    v_mfma_f32_32x32x16_bf16 v[48:63], a[32:35], v[96:99], v[48:63]
    s_mul_i32 s86, s69, 14336
    ds_read_b64_tr_b16 a[52:53], v29 offset:11648
    ds_read_b64_tr_b16 a[54:55], v29 offset:11872
    s_waitcnt lgkmcnt(8)
    v_mfma_f32_32x32x16_bf16 v[48:63], a[36:39], v[96:99], v[48:63]
    s_mul_i32 s87, s69, 11264
    s_add_u32 s87, s87, 114688
    ds_read_b64_tr_b16 a[56:57], v29 offset:12544
    ds_read_b64_tr_b16 a[58:59], v29 offset:12768
    s_waitcnt lgkmcnt(8)
    v_mfma_f32_32x32x16_bf16 v[48:63], a[40:43], v[96:99], v[48:63]
    s_mul_i32 s88, s69, 100352
    ds_read_b64_tr_b16 a[60:61], v29 offset:13440
    ds_read_b64_tr_b16 a[62:63], v29 offset:13664
    s_waitcnt lgkmcnt(8)
    v_mfma_f32_32x32x16_bf16 v[48:63], a[44:47], v[96:99], v[48:63]
    s_mul_i32 s89, s69, 401408
    s_and_b32 s93, s70, 3
    ds_read_b64_tr_b16 a[64:65], v29 offset:14336
    ds_read_b64_tr_b16 a[66:67], v29 offset:14560
    s_waitcnt lgkmcnt(8)
    v_mfma_f32_32x32x16_bf16 v[48:63], a[48:51], v[96:99], v[48:63]
    s_lshl_b32 s93, s93, 1
    s_add_u32 s93, s93, s71
    ds_read_b64_tr_b16 a[68:69], v29 offset:15232
    ds_read_b64_tr_b16 a[70:71], v29 offset:15456
    s_waitcnt lgkmcnt(8)
    v_mfma_f32_32x32x16_bf16 v[48:63], a[52:55], v[96:99], v[48:63]
    s_cmp_ge_u32 s93, 7
    ds_read_b64_tr_b16 a[72:73], v29 offset:16128
    ds_read_b64_tr_b16 a[74:75], v29 offset:16352
    s_waitcnt lgkmcnt(8)
    v_mfma_f32_32x32x16_bf16 v[48:63], a[56:59], v[96:99], v[48:63]
    s_cselect_b32 s80, 7, 0
    s_sub_u32 s93, s93, s80
    ds_read_b64_tr_b16 a[76:77], v29 offset:17024
    ds_read_b64_tr_b16 a[78:79], v29 offset:17248
    s_waitcnt lgkmcnt(8)
    v_mfma_f32_32x32x16_bf16 v[48:63], a[60:63], v[96:99], v[48:63]
    v_mul_u32_u24 v4, 896, v100
    ds_read_b64_tr_b16 a[80:81], v29 offset:17920
    ds_read_b64_tr_b16 a[82:83], v29 offset:18144
    s_waitcnt lgkmcnt(8)
    v_mfma_f32_32x32x16_bf16 v[48:63], a[64:67], v[96:99], v[48:63]
    s_lshl_b32 s80, s81, 7
    v_add3_u32 v24, v4, v101, s80
    ds_read_b64_tr_b16 a[84:85], v29 offset:18816
    ds_read_b64_tr_b16 a[86:87], v29 offset:19040
    s_waitcnt lgkmcnt(8)
    v_mfma_f32_32x32x16_bf16 v[48:63], a[68:71], v[96:99], v[48:63]
    v_mul_u32_u24 v4, 3584, v100
    s_lshl_b32 s80, s81, 9
    ds_read_b64_tr_b16 a[88:89], v29 offset:19712
    ds_read_b64_tr_b16 a[90:91], v29 offset:19936
    s_waitcnt lgkmcnt(8)
    v_mfma_f32_32x32x16_bf16 v[48:63], a[72:75], v[96:99], v[48:63]
    s_lshl_b32 s82, s69, 7
    ds_read_b64_tr_b16 a[92:93], v29 offset:20608
    ds_read_b64_tr_b16 a[94:95], v29 offset:20832
    s_waitcnt lgkmcnt(8)
    v_mfma_f32_32x32x16_bf16 v[48:63], a[76:79], v[96:99], v[48:63]
    s_add_u32 s80, s80, s82
    v_add3_u32 v26, v4, v101, s80
    ds_read_b64_tr_b16 a[96:97], v29 offset:21504
    ds_read_b64_tr_b16 a[98:99], v29 offset:21728
    s_waitcnt lgkmcnt(8)
    v_mfma_f32_32x32x16_bf16 v[48:63], a[80:83], v[96:99], v[48:63]
    s_lshl_b32 s80, s73, 6
    ds_read_b64_tr_b16 a[100:101], v29 offset:22400
    ds_read_b64_tr_b16 a[102:103], v29 offset:22624
    s_waitcnt lgkmcnt(8)
    v_mfma_f32_32x32x16_bf16 v[48:63], a[84:87], v[96:99], v[48:63]
    v_xor_b32 v103, v103, v102
    v_xor_b32 v102, s80, v103
    ds_read_b64_tr_b16 a[104:105], v29 offset:23296
    ds_read_b64_tr_b16 a[106:107], v29 offset:23520
    s_waitcnt lgkmcnt(8)
    v_mfma_f32_32x32x16_bf16 v[48:63], a[88:91], v[96:99], v[48:63]
    s_lshl_b32 s83, s81, 13
    v_lshrrev_b32 v5, 5, v0
    ds_read_b64_tr_b16 a[108:109], v29 offset:24192
    ds_read_b64_tr_b16 a[110:111], v29 offset:24416
    s_waitcnt lgkmcnt(8)
    v_mfma_f32_32x32x16_bf16 v[48:63], a[92:95], v[96:99], v[48:63]
    v_lshlrev_b32 v6, 4, v5
    s_waitcnt lgkmcnt(6)
    v_mfma_f32_32x32x16_bf16 v[48:63], a[96:99], v[96:99], v[48:63]
    v_xor_b32 v124, v104, v6
    v_xor_b32 v124, s80, v124
    s_waitcnt lgkmcnt(4)
    v_mfma_f32_32x32x16_bf16 v[48:63], a[100:103], v[96:99], v[48:63]
    v_lshl_add_u32 v124, v5, 3, v124
    s_waitcnt lgkmcnt(2)
    v_mfma_f32_32x32x16_bf16 v[48:63], a[104:107], v[96:99], v[48:63]
    v_add_u32 v124, s83, v124
    v_xor_b32 v125, 16, v124
    s_waitcnt lgkmcnt(0)
    v_mfma_f32_32x32x16_bf16 v[48:63], a[108:111], v[96:99], v[48:63]
    v_xor_b32 v126, 32, v124
    v_xor_b32 v127, 48, v124
    s_branch L_csdone
L_kv:
    v_mul_u32_u24 v4, 3584, v100
    s_min_u32 s82, s70, 27
    s_lshl_b32 s80, s82, 7
    s_mul_i32 s81, s69, 401408
    s_add_u32 s80, s80, s81
    v_add3_u32 v26, v4, v101, s80
    v_sub_f32 v32, v32, v48
    v_mul_f32 v32, v32, v28
    v_sub_f32 v33, v33, v49
    v_mul_f32 v33, v33, v28
    v_sub_f32 v34, v34, v50
    v_mul_f32 v34, v34, v28
    v_sub_f32 v35, v35, v51
    v_mul_f32 v35, v35, v28
    v_sub_f32 v36, v36, v52
    v_mul_f32 v36, v36, v28
    v_sub_f32 v37, v37, v53
    v_mul_f32 v37, v37, v28
    v_sub_f32 v38, v38, v54
    v_mul_f32 v38, v38, v28
    v_sub_f32 v39, v39, v55
    v_mul_f32 v39, v39, v28
    v_sub_f32 v40, v40, v56
    v_mul_f32 v40, v40, v28
    v_sub_f32 v41, v41, v57
    v_mul_f32 v41, v41, v28
    v_sub_f32 v42, v42, v58
    v_mul_f32 v42, v42, v28
    v_sub_f32 v43, v43, v59
    v_mul_f32 v43, v43, v28
    v_sub_f32 v44, v44, v60
    v_mul_f32 v44, v44, v28
    v_sub_f32 v45, v45, v61
    v_mul_f32 v45, v45, v28
    v_sub_f32 v46, v46, v62
    v_mul_f32 v46, v46, v28
    v_sub_f32 v47, v47, v63
    v_mul_f32 v47, v47, v28
    s_mov_b64 exec, s[76:77]
    v_mov_b32 v44, 0
    v_mov_b32 v45, 0
    v_mov_b32 v46, 0
    v_mov_b32 v47, 0
    s_mov_b64 exec, -1
    v_cvt_pk_bf16_f32 v64, v32, v33
    v_cvt_pk_bf16_f32 v65, v34, v35
    v_cvt_pk_bf16_f32 v66, v36, v37
    v_cvt_pk_bf16_f32 v67, v38, v39
    v_cvt_pk_bf16_f32 v68, v40, v41
    v_cvt_pk_bf16_f32 v69, v42, v43
    v_cvt_pk_bf16_f32 v70, v44, v45
    v_cvt_pk_bf16_f32 v71, v46, v47
    s_lshl_b32 s84, s74, 12
    s_cmp_eq_u32 s73, 1
    s_cbranch_scc1 L_v
    s_mov_b64 exec, s[76:77]
    v_mov_b32 v70, 1065369472
    v_mov_b32 v71, 0x3f80
    s_mov_b64 exec, -1
    buffer_store_dwordx4 v[64:67], v1, s[16:19], s84 offen sc1
    buffer_store_dwordx4 v[68:71], v1, s[16:19], s84 offen offset:1024 sc1
    v_mul_f32 v72, v32, v32
    v_fma_f32 v72, v33, v33, v72
    v_fma_f32 v72, v34, v34, v72
    v_fma_f32 v72, v35, v35, v72
    v_fma_f32 v72, v36, v36, v72
    v_fma_f32 v72, v37, v37, v72
    v_fma_f32 v72, v38, v38, v72
    v_fma_f32 v72, v39, v39, v72
    v_fma_f32 v72, v40, v40, v72
    v_fma_f32 v72, v41, v41, v72
    v_fma_f32 v72, v42, v42, v72
    v_fma_f32 v72, v43, v43, v72
    v_fma_f32 v72, v44, v44, v72
    v_fma_f32 v72, v45, v45, v72
    v_fma_f32 v72, v46, v46, v72
    v_fma_f32 v72, v47, v47, v72
    v_mov_b32 v73, v72
    s_nop 1
    v_permlane32_swap_b32 v72, v73
    v_add_f32 v72, v72, v73
    v_mov_b32 v73, 159848
    ds_max_u32 v73, v72
    s_branch L_kvdone
L_v:
    s_mov_b64 exec, s[76:77]
    v_mov_b32 v70, 0x3f80
    s_mov_b64 exec, -1
    s_lshl_b32 s80, s72, 12
    s_add_u32 s80, s80, 81920
    v_and_b32 v72, 31, v0
    v_bfe_u32 v74, v72, 1, 1
    v_lshlrev_b32 v74, 6, v74
    v_lshrrev_b32 v73, 5, v0
    v_lshl_add_u32 v73, v73, 3, v74
    v_lshl_add_u32 v72, v72, 7, v73
    v_add_u32 v72, s80, v72
    v_add3_u32 v73, v3, v103, s80
    ds_write_b64 v72, v[64:65] offset:0
    ds_write_b64 v72, v[66:67] offset:16
    ds_write_b64 v72, v[68:69] offset:32
    ds_write_b64 v72, v[70:71] offset:48
    ds_read_b64_tr_b16 v[76:77], v73 offset:0
    ds_read_b64_tr_b16 v[78:79], v73 offset:1024
    ds_read_b64_tr_b16 v[80:81], v73 offset:2048
    ds_read_b64_tr_b16 v[82:83], v73 offset:3072
    s_waitcnt lgkmcnt(0)
    buffer_store_dwordx4 v[76:79], v1, s[16:19], s84 offen offset:2048 sc1
    buffer_store_dwordx4 v[80:83], v1, s[16:19], s84 offen offset:3072 sc1
L_kvdone:
    s_waitcnt vmcnt(3)
    s_mov_b32 s90, 0
    v_mov_b32 v7, 0
L_ns_47:
    v_readfirstlane_b32 s66, v30
    v_readfirstlane_b32 s67, v31
    s_add_u32 s90, s90, 1
    s_cmp_lg_u64 s[66:67], 0
    s_cbranch_scc1 L_nk_48
    s_cmp_ge_u32 s90, 20000
    s_cbranch_scc1 L_nk_48
    buffer_load_dwordx2 v[30:31], v7, s[32:35], 0 offen sc1
    s_waitcnt vmcnt(0)
    s_branch L_ns_47
L_nk_48:
    s_waitcnt vmcnt(0)
    s_mov_b64 exec, 1
    v_mov_b32 v4, 159816
    v_mov_b32 v5, 1
    ds_add_rtn_u32 v5, v4, v5
    ds_read_b32 v6, v4 offset:32
    s_lshl_b32 s80, s70, 7
    s_add_u32 s80, s80, 294912
    s_waitcnt lgkmcnt(0)
    v_readfirstlane_b32 s81, v5
    s_cmp_lg_u32 s81, 3
    s_cbranch_scc1 L_sg_49
    v_readfirstlane_b32 s81, v6
    s_mov_b64 exec, 255
    v_mov_b32 v4, s66
    v_mov_b32 v5, s67
    v_mov_b32 v6, s81
    buffer_store_dwordx4 v[4:7], v1, s[16:19], s80 offen sc1
L_sg_49:
    s_mov_b64 exec, -1
    s_nop 0
    v_mov_b32 v4, 159744
    s_mov_b32 s90, 0
L_ls_50:
    ds_read_b32 v5, v4
    s_add_u32 s90, s90, 1
    s_waitcnt lgkmcnt(0)
    v_readfirstlane_b32 s100, v5
    s_cmp_ge_u32 s100, 8
    s_cbranch_scc1 L_lk_51
    s_cmp_lt_u32 s90, 400000
    s_cbranch_scc1 L_ls_50
L_lk_51:
    s_add_u32 m0, s86, 0
    s_mov_b32 s80, 0
    buffer_load_dwordx4 v26, s[12:15], s80 offen lds
    s_add_u32 m0, s86, 1024
    s_mov_b32 s80, 28672
    buffer_load_dwordx4 v26, s[12:15], s80 offen lds
    s_add_u32 m0, s86, 2048
    s_mov_b32 s80, 57344
    buffer_load_dwordx4 v26, s[12:15], s80 offen lds
    s_add_u32 m0, s86, 3072
    s_mov_b32 s80, 86016
    buffer_load_dwordx4 v26, s[12:15], s80 offen lds
    s_add_u32 m0, s86, 4096
    s_mov_b32 s80, 114688
    buffer_load_dwordx4 v26, s[12:15], s80 offen lds
    s_add_u32 m0, s86, 5120
    s_mov_b32 s80, 143360
    buffer_load_dwordx4 v26, s[12:15], s80 offen lds
    s_add_u32 m0, s86, 6144
    s_mov_b32 s80, 172032
    buffer_load_dwordx4 v26, s[12:15], s80 offen lds
    s_add_u32 m0, s86, 7168
    s_mov_b32 s80, 200704
    buffer_load_dwordx4 v26, s[12:15], s80 offen lds
    s_add_u32 m0, s86, 8192
    s_mov_b32 s80, 229376
    buffer_load_dwordx4 v26, s[12:15], s80 offen lds
    s_add_u32 m0, s86, 9216
    s_mov_b32 s80, 258048
    buffer_load_dwordx4 v26, s[12:15], s80 offen lds
    s_add_u32 m0, s86, 10240
    s_mov_b32 s80, 286720
    buffer_load_dwordx4 v26, s[12:15], s80 offen lds
    s_add_u32 m0, s86, 11264
    s_mov_b32 s80, 315392
    buffer_load_dwordx4 v26, s[12:15], s80 offen lds
    s_add_u32 m0, s86, 12288
    s_mov_b32 s80, 344064
    buffer_load_dwordx4 v26, s[12:15], s80 offen lds
    s_add_u32 m0, s86, 13312
    s_mov_b32 s80, 372736
    buffer_load_dwordx4 v26, s[12:15], s80 offen lds
    v_add3_u32 v72, v3, v103, s86
    v_xor_b32 v73, 64, v72
    s_waitcnt vmcnt(0)
    ds_read_b64_tr_b16 a[0:1], v72 offset:0
    ds_read_b64_tr_b16 a[2:3], v72 offset:1024
    ds_read_b64_tr_b16 a[4:5], v73 offset:0
    ds_read_b64_tr_b16 a[6:7], v73 offset:1024
    ds_read_b64_tr_b16 a[8:9], v72 offset:2048
    ds_read_b64_tr_b16 a[10:11], v72 offset:3072
    ds_read_b64_tr_b16 a[12:13], v73 offset:2048
    ds_read_b64_tr_b16 a[14:15], v73 offset:3072
    ds_read_b64_tr_b16 a[16:17], v72 offset:4096
    ds_read_b64_tr_b16 a[18:19], v72 offset:5120
    ds_read_b64_tr_b16 a[20:21], v73 offset:4096
    ds_read_b64_tr_b16 a[22:23], v73 offset:5120
    ds_read_b64_tr_b16 a[24:25], v72 offset:6144
    ds_read_b64_tr_b16 a[26:27], v72 offset:7168
    ds_read_b64_tr_b16 a[28:29], v73 offset:6144
    ds_read_b64_tr_b16 a[30:31], v73 offset:7168
    ds_read_b64_tr_b16 a[32:33], v72 offset:8192
    ds_read_b64_tr_b16 a[34:35], v72 offset:9216
    ds_read_b64_tr_b16 a[36:37], v73 offset:8192
    ds_read_b64_tr_b16 a[38:39], v73 offset:9216
    ds_read_b64_tr_b16 a[40:41], v72 offset:10240
    ds_read_b64_tr_b16 a[42:43], v72 offset:11264
    ds_read_b64_tr_b16 a[44:45], v73 offset:10240
    ds_read_b64_tr_b16 a[46:47], v73 offset:11264
    ds_read_b64_tr_b16 a[48:49], v72 offset:12288
    ds_read_b64_tr_b16 a[50:51], v72 offset:13312
    ds_read_b64_tr_b16 a[52:53], v73 offset:12288
    ds_read_b64_tr_b16 a[54:55], v73 offset:13312
    s_waitcnt lgkmcnt(15)
    v_mfma_f32_32x32x16_bf16 v[32:47], v[96:99], a[0:3], 0
    v_mfma_f32_32x32x16_bf16 v[48:63], v[96:99], a[4:7], 0
    v_mfma_f32_32x32x16_bf16 v[32:47], v[96:99], a[8:11], v[32:47]
    v_mfma_f32_32x32x16_bf16 v[48:63], v[96:99], a[12:15], v[48:63]
    v_mfma_f32_32x32x16_bf16 v[32:47], v[96:99], a[16:19], v[32:47]
    v_mfma_f32_32x32x16_bf16 v[48:63], v[96:99], a[20:23], v[48:63]
    s_waitcnt lgkmcnt(14)
    v_mfma_f32_32x32x16_bf16 v[32:47], v[96:99], a[24:27], v[32:47]
    s_waitcnt lgkmcnt(12)
    v_mfma_f32_32x32x16_bf16 v[48:63], v[96:99], a[28:31], v[48:63]
    s_waitcnt lgkmcnt(10)
    v_mfma_f32_32x32x16_bf16 v[32:47], v[96:99], a[32:35], v[32:47]
    s_waitcnt lgkmcnt(8)
    v_mfma_f32_32x32x16_bf16 v[48:63], v[96:99], a[36:39], v[48:63]
    s_waitcnt lgkmcnt(6)
    v_mfma_f32_32x32x16_bf16 v[32:47], v[96:99], a[40:43], v[32:47]
    s_waitcnt lgkmcnt(4)
    v_mfma_f32_32x32x16_bf16 v[48:63], v[96:99], a[44:47], v[48:63]
    s_waitcnt lgkmcnt(2)
    v_mfma_f32_32x32x16_bf16 v[32:47], v[96:99], a[48:51], v[32:47]
    s_waitcnt lgkmcnt(0)
    v_mfma_f32_32x32x16_bf16 v[48:63], v[96:99], a[52:55], v[48:63]
    s_lshl_b32 s80, s69, 8
    s_add_u32 s80, s80, 90112
    v_lshlrev_b32 v73, 2, v0
    v_add_u32 v74, s80, v73
    s_nop 7
    v_cndmask_b32 v72, v32, v48, s[76:77]
    ds_write_b32 v74, v72
    s_mov_b64 exec, 1
    v_mov_b32 v4, 159772
    v_mov_b32 v5, 1
    ds_add_u32 v4, v5
    s_mov_b64 exec, -1
    s_cmp_gt_u32 s70, 27
    s_cbranch_scc1 L_kvend
    s_cmp_lg_u32 s69, 0
    s_cbranch_scc1 L_kvend
    v_mov_b32 v4, 159772
    s_mov_b32 s90, 0
L_ls_52:
    ds_read_b32 v5, v4
    s_add_u32 s90, s90, 1
    s_waitcnt lgkmcnt(0)
    v_readfirstlane_b32 s100, v5
    s_cmp_ge_u32 s100, 4
    s_cbranch_scc1 L_lk_53
    s_cmp_lt_u32 s90, 400000
    s_cbranch_scc1 L_ls_52
L_lk_53:
    ds_read_b32 v75, v74 offset:256
    ds_read_b32 v76, v74 offset:512
    ds_read_b32 v77, v74 offset:768
    s_lshl_b32 s81, s70, 9
    s_add_u32 s81, s81, 262144
    v_lshlrev_b32 v74, 3, v0
    s_waitcnt lgkmcnt(0)
    v_add_f32 v72, v72, v75
    v_add_f32 v73, v76, v77
    buffer_store_dwordx2 v[72:73], v74, s[16:19], s81 offen sc1
    s_lshl_b32 s80, s70, 7
    s_add_u32 s80, s80, 299008
    v_mov_b32 v4, s66
    v_mov_b32 v5, s67
    s_waitcnt vmcnt(0)
    s_mov_b64 exec, 0xff
    buffer_store_dwordx4 v[4:7], v1, s[16:19], s80 offen sc1
    s_mov_b64 exec, -1
L_kvend:
    s_cmp_lg_u32 s69, 0
    s_cbranch_scc1 L_gw_56
    s_lshl_b32 s80, s70, 10
    s_add_u32 s80, s80, 327680
    v_lshlrev_b32 v5, 7, v0
    v_add_u32 v5, s80, v5
    s_mov_b32 s78, 4294967041
    s_mov_b32 s79, -1
    s_mov_b64 vcc, s[78:79]
    v_mov_b32 v7, 2147418112
    v_cndmask_b32 v6, v5, v7, vcc
    s_mov_b32 s90, 0
L_gs_54:
    buffer_load_dwordx4 v[32:35], v6, s[16:19], 0 offen sc1
    s_add_u32 s90, s90, 1
    s_waitcnt vmcnt(0)
    v_cmp_eq_u64 vcc, s[66:67], v[32:33]
    s_or_b64 vcc, vcc, s[78:79]
    s_cmp_eq_u64 vcc, -1
    s_cbranch_scc1 L_gk_55
    s_cmp_lt_u32 s90, 20000
    s_cbranch_scc1 L_gs_54
L_gk_55:
    s_mov_b32 s82, 0xfe
    v_cmp_eq_u32 vcc, s75, v34
    s_and_b32 s80, vcc_lo, s82
    s_cmp_eq_u32 s80, s82
    s_cselect_b32 s80, 1, 0
    v_mov_b32 v4, 159856
    v_mov_b32 v5, s80
    ds_write_b32 v4, v5
    s_mov_b64 exec, 1
    v_mov_b32 v4, 159824
    v_mov_b32 v5, 1
    ds_add_u32 v4, v5
    s_mov_b64 exec, -1
L_gw_56:
    v_mov_b32 v4, 159824
    s_mov_b32 s90, 0
L_ls_57:
    ds_read_b32 v5, v4
    s_add_u32 s90, s90, 1
    s_waitcnt lgkmcnt(0)
    v_readfirstlane_b32 s100, v5
    s_cmp_ge_u32 s100, 1
    s_cbranch_scc1 L_lk_58
    s_cmp_lt_u32 s90, 400000
    s_cbranch_scc1 L_ls_57
L_lk_58:
    s_mov_b64 exec, 1
    v_mov_b32 v4, 159784
    v_mov_b32 v5, 1
    ds_add_u32 v4, v5
    s_mov_b64 exec, -1
    v_mov_b32 v4, 159856
    ds_read_b32 v5, v4
    s_waitcnt lgkmcnt(0)
    v_readfirstlane_b32 s3, v5
    s_lshl_b32 s80, s70, 2
    s_add_u32 s80, s80, s69
    s_mul_i32 s81, s80, 12544
    s_mul_i32 s82, s80, 3136
    v_lshlrev_b32 v74, 7, v0
    buffer_load_dword v84, v74, s[20:23], s81 offen
    s_add_u32 s81, s81, 8192
    s_bfm_b64 exec, 34, 0
    buffer_load_dword v85, v74, s[20:23], s81 offen
    s_bfm_b64 exec, 25, 0
    buffer_load_dword v86, v74, s[24:27], s82 offen
    s_mov_b64 exec, -1
    s_setprio 0
    s_cmp_eq_u32 s3, 0
    s_cbranch_scc1 L_kvquit
    v_lshlrev_b32 v36, 7, v0
    v_and_b32 v37, 7, v0
    v_lshrrev_b32 v38, 3, v0
    v_lshlrev_b32 v38, 15, v38
    v_lshl_add_u32 v37, v37, 7, v38
    s_lshl_b32 s80, s70, 10
    s_add_u32 s80, s80, 360448
    s_lshl_b32 s83, s69, 13
    s_bfm_b64 exec, 32, 0
    buffer_load_dword a0, v37, s[16:19], s80 offen sc1
    s_mov_b64 exec, -1
    s_mul_i32 s81, s70, 57344
    s_add_u32 s81, s81, 3145728
    s_add_u32 s82, s81, 57344
    s_add_u32 s81, s81, s83
    s_cmp_lt_u32 s81, s82
    s_cselect_b32 s80, s81, 2147418112
    s_add_u32 s81, s81, 32768
    s_mov_b64 exec, -1
    buffer_load_dword a1, v36, s[16:19], s80 offen sc1
    s_mov_b64 exec, -1
    s_waitcnt vmcnt(0)
    s_cmp_lt_u32 s81, s82
    s_cselect_b32 s80, s81, 2147418112
    s_add_u32 s81, s81, 32768
    s_mov_b64 exec, -1
    buffer_load_dword a2, v36, s[16:19], s80 offen sc1
    s_mov_b64 exec, -1
    s_waitcnt vmcnt(0)
    s_mul_i32 s81, s70, 7168
    s_add_u32 s81, s81, 2883584
    s_add_u32 s82, s81, 7168
    s_add_u32 s81, s81, s83
    s_cmp_lt_u32 s81, s82
    s_cselect_b32 s80, s81, 2147418112
    s_add_u32 s81, s81, 32768
    s_bfm_b64 exec, 56, 0
    buffer_load_dword a3, v36, s[16:19], s80 offen sc1
    s_mov_b64 exec, -1
    s_waitcnt vmcnt(0)
    s_mul_i32 s81, s70, 65536
    s_add_u32 s81, s81, 12582912
    s_add_u32 s82, s81, 65536
    s_add_u32 s81, s81, s83
    s_cmp_lt_u32 s81, s82
    s_cselect_b32 s80, s81, 2147418112
    s_add_u32 s81, s81, 32768
    s_mov_b64 exec, -1
    buffer_load_dword a4, v36, s[16:19], s80 offen sc1
    s_mov_b64 exec, -1
    s_waitcnt vmcnt(0)
    s_cmp_lt_u32 s81, s82
    s_cselect_b32 s80, s81, 2147418112
    s_add_u32 s81, s81, 32768
    s_mov_b64 exec, -1
    buffer_load_dword a5, v36, s[16:19], s80 offen sc1
    s_mov_b64 exec, -1
    s_waitcnt vmcnt(0)
L_kvquit:
    s_endpgm
L_att:
    s_mul_i32 s80, s71, 112
    s_lshl_b32 s81, s69, 3
    v_add_u32 v4, s81, v100
    v_mul_u32_u24 v4, 896, v4
    v_add3_u32 v109, v4, v101, s80
    s_lshl_b32 s86, s69, 10
    s_mul_i32 s80, s73, 56
    v_add_u32 v103, s80, v103
    v_xor_b32 v103, v103, v102
    v_add_u32 v4, v2, v103
    v_add_u32 v10, 114688, v4
    v_add_u32 v11, 57344, v4
    s_add_u32 m0, s86, 114688
    s_mov_b32 s80, 0
    buffer_load_dwordx4 v109, s[12:15], s80 offen lds
    s_add_u32 m0, s86, 118784
    s_mov_b32 s80, 28672
    buffer_load_dwordx4 v109, s[12:15], s80 offen lds
    s_add_u32 m0, s86, 122880
    s_mov_b32 s80, 57344
    buffer_load_dwordx4 v109, s[12:15], s80 offen lds
    s_add_u32 m0, s86, 126976
    s_mov_b32 s80, 86016
    buffer_load_dwordx4 v109, s[12:15], s80 offen lds
    s_add_u32 m0, s86, 131072
    s_mov_b32 s80, 114688
    buffer_load_dwordx4 v109, s[12:15], s80 offen lds
    s_add_u32 m0, s86, 135168
    s_mov_b32 s80, 143360
    buffer_load_dwordx4 v109, s[12:15], s80 offen lds
    s_add_u32 m0, s86, 139264
    s_mov_b32 s80, 172032
    buffer_load_dwordx4 v109, s[12:15], s80 offen lds
    s_add_u32 m0, s86, 143360
    s_mov_b32 s80, 200704
    buffer_load_dwordx4 v109, s[12:15], s80 offen lds
    s_add_u32 m0, s86, 147456
    s_mov_b32 s80, 229376
    buffer_load_dwordx4 v109, s[12:15], s80 offen lds
    s_add_u32 m0, s86, 151552
    s_mov_b32 s80, 258048
    buffer_load_dwordx4 v109, s[12:15], s80 offen lds
    s_add_u32 m0, s86, 155648
    s_mov_b32 s80, 286720
    buffer_load_dwordx4 v109, s[12:15], s80 offen lds
    s_waitcnt vmcnt(11)
    s_barrier
    ds_read_b128 v[16:19], v108 offset:0
    ds_read_b128 v[20:23], v108 offset:8192
    ds_read_b128 v[88:91], v108 offset:16384
    ds_read_b128 v[92:95], v108 offset:24576
    ds_read_b128 v[112:115], v108 offset:32768
    ds_read_b128 v[116:119], v108 offset:40960
    ds_read_b128 v[120:123], v108 offset:49152
    s_waitcnt lgkmcnt(6)
    v_dot2c_f32_bf16 v30, s85, v16
    v_dot2c_f32_bf16 v31, v16, v16
    v_dot2c_f32_bf16 v30, s85, v17
    v_dot2c_f32_bf16 v31, v17, v17
    v_dot2c_f32_bf16 v30, s85, v18
    v_dot2c_f32_bf16 v31, v18, v18
    v_dot2c_f32_bf16 v30, s85, v19
    v_dot2c_f32_bf16 v31, v19, v19
    s_waitcnt lgkmcnt(5)
    v_dot2c_f32_bf16 v30, s85, v20
    v_dot2c_f32_bf16 v31, v20, v20
    v_dot2c_f32_bf16 v30, s85, v21
    v_dot2c_f32_bf16 v31, v21, v21
    v_dot2c_f32_bf16 v30, s85, v22
    v_dot2c_f32_bf16 v31, v22, v22
    v_dot2c_f32_bf16 v30, s85, v23
    v_dot2c_f32_bf16 v31, v23, v23
    s_waitcnt lgkmcnt(4)
    v_dot2c_f32_bf16 v30, s85, v88
    v_dot2c_f32_bf16 v31, v88, v88
    v_dot2c_f32_bf16 v30, s85, v89
    v_dot2c_f32_bf16 v31, v89, v89
    v_dot2c_f32_bf16 v30, s85, v90
    v_dot2c_f32_bf16 v31, v90, v90
    v_dot2c_f32_bf16 v30, s85, v91
    v_dot2c_f32_bf16 v31, v91, v91
    s_waitcnt lgkmcnt(3)
    v_dot2c_f32_bf16 v30, s85, v92
    v_dot2c_f32_bf16 v31, v92, v92
    v_dot2c_f32_bf16 v30, s85, v93
    v_dot2c_f32_bf16 v31, v93, v93
    v_dot2c_f32_bf16 v30, s85, v94
    v_dot2c_f32_bf16 v31, v94, v94
    v_dot2c_f32_bf16 v30, s85, v95
    v_dot2c_f32_bf16 v31, v95, v95
    s_waitcnt lgkmcnt(2)
    v_dot2c_f32_bf16 v30, s85, v112
    v_dot2c_f32_bf16 v31, v112, v112
    v_dot2c_f32_bf16 v30, s85, v113
    v_dot2c_f32_bf16 v31, v113, v113
    v_dot2c_f32_bf16 v30, s85, v114
    v_dot2c_f32_bf16 v31, v114, v114
    v_dot2c_f32_bf16 v30, s85, v115
    v_dot2c_f32_bf16 v31, v115, v115
    s_waitcnt lgkmcnt(1)
    v_dot2c_f32_bf16 v30, s85, v116
    v_dot2c_f32_bf16 v31, v116, v116
    v_dot2c_f32_bf16 v30, s85, v117
    v_dot2c_f32_bf16 v31, v117, v117
    v_dot2c_f32_bf16 v30, s85, v118
    v_dot2c_f32_bf16 v31, v118, v118
    v_dot2c_f32_bf16 v30, s85, v119
    v_dot2c_f32_bf16 v31, v119, v119
    s_waitcnt lgkmcnt(0)
    v_dot2c_f32_bf16 v30, s85, v120
    v_dot2c_f32_bf16 v31, v120, v120
    v_dot2c_f32_bf16 v30, s85, v121
    v_dot2c_f32_bf16 v31, v121, v121
    v_dot2c_f32_bf16 v30, s85, v122
    v_dot2c_f32_bf16 v31, v122, v122
    v_dot2c_f32_bf16 v30, s85, v123
    v_dot2c_f32_bf16 v31, v123, v123
    s_nop 2
    v_mov_b32 v6, v30
    s_nop 1
    v_permlane32_swap_b32 v30, v6
    v_mov_b32 v7, v31
    s_nop 1
    v_permlane32_swap_b32 v31, v7
    v_add_f32 v30, v30, v6
    v_add_f32 v31, v31, v7
    ds_write_b64 v111, v[30:31]
    s_waitcnt lgkmcnt(0)
    s_barrier
    s_add_u32 m0, s86, 57344
    s_mov_b32 s80, 315392
    buffer_load_dwordx4 v109, s[12:15], s80 offen lds
    s_add_u32 m0, s86, 61440
    s_mov_b32 s80, 344064
    buffer_load_dwordx4 v109, s[12:15], s80 offen lds
    s_add_u32 m0, s86, 65536
    s_mov_b32 s80, 372736
    buffer_load_dwordx4 v109, s[12:15], s80 offen lds
    v_mov_b32 v7, 0
    buffer_load_dwordx2 v[12:13], v7, s[32:35], 0 offen sc1
    v_lshlrev_b32 v4, 7, v0
    s_mov_b64 exec, 255
    buffer_load_dword a127, v4, s[8:11], s96 offen
    s_mov_b64 exec, -1
    ds_read_b64 v[112:113], v110 offset:0
    ds_read_b64 v[114:115], v110 offset:256
    ds_read_b64 v[116:117], v110 offset:512
    ds_read_b64 v[118:119], v110 offset:768
    ds_read_b128 a[0:3], v104 offset:0
    ds_read_b128 a[4:7], v105 offset:0
    ds_read_b128 a[8:11], v106 offset:0
    ds_read_b128 a[12:15], v107 offset:0
    ds_read_b128 a[16:19], v104 offset:8192
    ds_read_b128 a[20:23], v105 offset:8192
    ds_read_b128 a[24:27], v106 offset:8192
    ds_read_b128 a[28:31], v107 offset:8192
    ds_read_b128 a[32:35], v104 offset:16384
    ds_read_b128 a[36:39], v105 offset:16384
    ds_read_b128 a[40:43], v106 offset:16384
    ds_read_b128 a[44:47], v107 offset:16384
    ds_read_b128 a[48:51], v104 offset:24576
    ds_read_b128 a[52:55], v105 offset:24576
    ds_read_b128 a[56:59], v106 offset:24576
    ds_read_b128 a[60:63], v107 offset:24576
    ds_read_b128 a[64:67], v104 offset:32768
    ds_read_b128 a[68:71], v105 offset:32768
    ds_read_b128 a[72:75], v106 offset:32768
    ds_read_b128 a[76:79], v107 offset:32768
    ds_read_b128 a[80:83], v104 offset:40960
    ds_read_b128 a[84:87], v105 offset:40960
    ds_read_b128 a[88:91], v106 offset:40960
    ds_read_b128 a[92:95], v107 offset:40960
    ds_read_b128 a[96:99], v104 offset:49152
    ds_read_b128 a[100:103], v105 offset:49152
    ds_read_b128 a[104:107], v106 offset:49152
    ds_read_b128 a[108:111], v107 offset:49152
    s_waitcnt lgkmcnt(15)
    v_add_f32 v112, v112, v114
    v_add_f32 v113, v113, v115
    v_add_f32 v116, v116, v118
    v_add_f32 v117, v117, v119
    v_add_f32 v112, v112, v116
    v_add_f32 v113, v113, v117
    v_mul_f32 v8, 0x3b124925, v112
    v_mul_f32 v112, v8, v8
    v_mul_f32 v113, 0x3b124925, v113
    v_sub_f32 v113, v113, v112
    v_max_f32 v9, 0, v113
    v_add_f32 v9, 0x3727c5ac, v9
    v_rsq_f32 v9, v9
    s_waitcnt lgkmcnt(0)
    s_mov_b64 exec, 1
    v_mov_b32 v4, 159744
    v_mov_b32 v5, 1
    ds_add_u32 v4, v5
    s_mov_b64 exec, -1
    v_mul_f32 v9, 0x3e8b97f6, v9
    s_waitcnt vmcnt(1)
    s_mov_b64 exec, 1
    v_mov_b32 v4, 159752
    v_mov_b32 v5, 1
    ds_add_u32 v4, v5
    s_mov_b64 exec, -1
    s_mov_b32 s90, 0
    v_mov_b32 v7, 0
L_ns_59:
    v_readfirstlane_b32 s66, v12
    v_readfirstlane_b32 s67, v13
    s_add_u32 s90, s90, 1
    s_cmp_lg_u64 s[66:67], 0
    s_cbranch_scc1 L_nk_60
    s_cmp_ge_u32 s90, 20000
    s_cbranch_scc1 L_nk_60
    buffer_load_dwordx2 v[12:13], v7, s[32:35], 0 offen sc1
    s_waitcnt vmcnt(0)
    s_branch L_ns_59
L_nk_60:
    s_lshl_b32 s80, s74, 4
    s_lshl_b32 s81, s71, 1
    s_add_u32 s80, s80, s81
    s_add_u32 s80, s80, s73
    s_lshl_b32 s80, s80, 11
    s_add_u32 s89, s80, 12582912
    v_mov_b32 v4, 159752
    s_mov_b32 s90, 0
L_ls_61:
    ds_read_b32 v5, v4
    s_add_u32 s90, s90, 1
    s_waitcnt lgkmcnt(0)
    v_readfirstlane_b32 s100, v5
    s_cmp_ge_u32 s100, 4
    s_cbranch_scc1 L_lk_62
    s_cmp_lt_u32 s90, 400000
    s_cbranch_scc1 L_ls_61
L_lk_62:
    ds_read_b64_tr_b16 v[64:65], v10 offset:0
    ds_read_b64_tr_b16 v[66:67], v10 offset:512
    ds_read_b64_tr_b16 v[68:69], v10 offset:2048
    ds_read_b64_tr_b16 v[70:71], v10 offset:2560
    ds_read_b64_tr_b16 v[72:73], v10 offset:4096
    ds_read_b64_tr_b16 v[74:75], v10 offset:4608
    ds_read_b64_tr_b16 v[76:77], v10 offset:6144
    ds_read_b64_tr_b16 v[78:79], v10 offset:6656
    ds_read_b64_tr_b16 v[80:81], v10 offset:8192
    ds_read_b64_tr_b16 v[82:83], v10 offset:8704
    ds_read_b64_tr_b16 v[84:85], v10 offset:10240
    ds_read_b64_tr_b16 v[86:87], v10 offset:10752
    ds_read_b64_tr_b16 v[88:89], v10 offset:12288
    ds_read_b64_tr_b16 v[90:91], v10 offset:12800
    s_waitcnt lgkmcnt(12)
    v_mfma_f32_32x32x16_bf16 v[32:47], v[64:67], a[0:3], 0
    v_mfma_f32_32x32x16_bf16 v[48:63], v[64:67], v[96:99], 0
    s_lshl_b32 s80, s69, 11
    ds_read_b64_tr_b16 v[92:93], v10 offset:14336
    ds_read_b64_tr_b16 v[94:95], v10 offset:14848
    s_waitcnt lgkmcnt(12)
    v_mfma_f32_32x32x16_bf16 v[32:47], v[68:71], a[4:7], v[32:47]
    v_mfma_f32_32x32x16_bf16 v[48:63], v[68:71], v[96:99], v[48:63]
    s_add_u32 s80, s80, 73728
    v_add_u32 v12, s80, v1
    ds_read_b64_tr_b16 v[64:65], v10 offset:16384
    ds_read_b64_tr_b16 v[66:67], v10 offset:16896
    s_waitcnt lgkmcnt(12)
    v_mfma_f32_32x32x16_bf16 v[32:47], v[72:75], a[8:11], v[32:47]
    v_mfma_f32_32x32x16_bf16 v[48:63], v[72:75], v[96:99], v[48:63]
    s_lshl_b32 s80, s69, 8
    s_add_u32 s80, s80, 160768
    ds_read_b64_tr_b16 v[68:69], v10 offset:18432
    ds_read_b64_tr_b16 v[70:71], v10 offset:18944
    s_waitcnt lgkmcnt(12)
    v_mfma_f32_32x32x16_bf16 v[32:47], v[76:79], a[12:15], v[32:47]
    v_mfma_f32_32x32x16_bf16 v[48:63], v[76:79], v[96:99], v[48:63]
    v_lshlrev_b32 v14, 2, v0
    v_add_u32 v15, s80, v14
    ds_read_b64_tr_b16 v[72:73], v10 offset:20480
    ds_read_b64_tr_b16 v[74:75], v10 offset:20992
    s_waitcnt lgkmcnt(12)
    v_mfma_f32_32x32x16_bf16 v[32:47], v[80:83], a[16:19], v[32:47]
    v_mfma_f32_32x32x16_bf16 v[48:63], v[80:83], v[96:99], v[48:63]
    v_add_u32 v14, 160768, v14
    s_add_u32 s80, s71, s70
    ds_read_b64_tr_b16 v[76:77], v10 offset:22528
    ds_read_b64_tr_b16 v[78:79], v10 offset:23040
    s_waitcnt lgkmcnt(12)
    v_mfma_f32_32x32x16_bf16 v[32:47], v[84:87], a[20:23], v[32:47]
    v_mfma_f32_32x32x16_bf16 v[48:63], v[84:87], v[96:99], v[48:63]
    s_and_b32 s80, s80, 3
    s_lshl_b32 s91, s80, 14
    ds_read_b64_tr_b16 v[80:81], v10 offset:24576
    ds_read_b64_tr_b16 v[82:83], v10 offset:25088
    s_waitcnt lgkmcnt(12)
    v_mfma_f32_32x32x16_bf16 v[32:47], v[88:91], a[24:27], v[32:47]
    v_mfma_f32_32x32x16_bf16 v[48:63], v[88:91], v[96:99], v[48:63]
    s_add_u32 s92, s91, 0x4000
    s_and_b32 s92, s92, 0xffff
    ds_read_b64_tr_b16 v[84:85], v10 offset:26624
    ds_read_b64_tr_b16 v[86:87], v10 offset:27136
    s_waitcnt lgkmcnt(12)
    v_mfma_f32_32x32x16_bf16 v[32:47], v[92:95], a[28:31], v[32:47]
    v_mfma_f32_32x32x16_bf16 v[48:63], v[92:95], v[96:99], v[48:63]
    s_lshl_b32 s80, s69, 16
    v_add_u32 v104, s80, v1
    ds_read_b64_tr_b16 v[88:89], v10 offset:28672
    ds_read_b64_tr_b16 v[90:91], v10 offset:29184
    s_waitcnt lgkmcnt(12)
    v_mfma_f32_32x32x16_bf16 v[32:47], v[64:67], a[32:35], v[32:47]
    v_mfma_f32_32x32x16_bf16 v[48:63], v[64:67], v[96:99], v[48:63]
    v_add_u32 v105, 4096, v104
    v_add_u32 v106, 8192, v104
    ds_read_b64_tr_b16 v[92:93], v10 offset:30720
    ds_read_b64_tr_b16 v[94:95], v10 offset:31232
    s_waitcnt lgkmcnt(12)
    v_mfma_f32_32x32x16_bf16 v[32:47], v[68:71], a[36:39], v[32:47]
    v_mfma_f32_32x32x16_bf16 v[48:63], v[68:71], v[96:99], v[48:63]
    v_add_u32 v107, 12288, v104
    ds_read_b64_tr_b16 v[64:65], v10 offset:32768
    ds_read_b64_tr_b16 v[66:67], v10 offset:33280
    s_waitcnt lgkmcnt(12)
    v_mfma_f32_32x32x16_bf16 v[32:47], v[72:75], a[40:43], v[32:47]
    v_mfma_f32_32x32x16_bf16 v[48:63], v[72:75], v[96:99], v[48:63]
    s_xor_b32 s80, s69, 0
    s_mul_i32 s80, s80, 12288
    ds_read_b64_tr_b16 v[68:69], v10 offset:34816
    ds_read_b64_tr_b16 v[70:71], v10 offset:35328
    s_waitcnt lgkmcnt(12)
    v_mfma_f32_32x32x16_bf16 v[32:47], v[76:79], a[44:47], v[32:47]
    v_mfma_f32_32x32x16_bf16 v[48:63], v[76:79], v[96:99], v[48:63]
    s_add_u32 s80, s80, 57344
    v_add_u32 v124, s80, v1
    ds_read_b64_tr_b16 v[72:73], v10 offset:36864
    ds_read_b64_tr_b16 v[74:75], v10 offset:37376
    s_waitcnt lgkmcnt(12)
    v_mfma_f32_32x32x16_bf16 v[32:47], v[80:83], a[48:51], v[32:47]
    v_mfma_f32_32x32x16_bf16 v[48:63], v[80:83], v[96:99], v[48:63]
    s_xor_b32 s80, s69, 1
    s_mul_i32 s80, s80, 12288
    ds_read_b64_tr_b16 v[76:77], v10 offset:38912
    ds_read_b64_tr_b16 v[78:79], v10 offset:39424
    s_waitcnt lgkmcnt(12)
    v_mfma_f32_32x32x16_bf16 v[32:47], v[84:87], a[52:55], v[32:47]
    v_mfma_f32_32x32x16_bf16 v[48:63], v[84:87], v[96:99], v[48:63]
    s_add_u32 s80, s80, 57344
    v_add_u32 v125, s80, v1
    ds_read_b64_tr_b16 v[80:81], v10 offset:40960
    ds_read_b64_tr_b16 v[82:83], v10 offset:41472
    s_waitcnt lgkmcnt(12)
    v_mfma_f32_32x32x16_bf16 v[32:47], v[88:91], a[56:59], v[32:47]
    v_mfma_f32_32x32x16_bf16 v[48:63], v[88:91], v[96:99], v[48:63]
    v_accvgpr_write_b32 a0, 0
    v_accvgpr_write_b32 a1, 0
    v_accvgpr_write_b32 a2, 0
    v_accvgpr_write_b32 a3, 0
    s_xor_b32 s80, s69, 2
    s_mul_i32 s80, s80, 12288
    ds_read_b64_tr_b16 v[84:85], v10 offset:43008
    ds_read_b64_tr_b16 v[86:87], v10 offset:43520
    s_waitcnt lgkmcnt(12)
    v_mfma_f32_32x32x16_bf16 v[32:47], v[92:95], a[60:63], v[32:47]
    v_mfma_f32_32x32x16_bf16 v[48:63], v[92:95], v[96:99], v[48:63]
    v_accvgpr_write_b32 a4, 0
    v_accvgpr_write_b32 a5, 0
    v_accvgpr_write_b32 a6, 0
    v_accvgpr_write_b32 a7, 0
    s_add_u32 s80, s80, 57344
    v_add_u32 v126, s80, v1
    ds_read_b64_tr_b16 v[88:89], v11 offset:0
    ds_read_b64_tr_b16 v[90:91], v11 offset:512
    s_waitcnt lgkmcnt(12)
    v_mfma_f32_32x32x16_bf16 v[32:47], v[64:67], a[64:67], v[32:47]
    v_mfma_f32_32x32x16_bf16 v[48:63], v[64:67], v[96:99], v[48:63]
    v_accvgpr_write_b32 a8, 0
    v_accvgpr_write_b32 a9, 0
    v_accvgpr_write_b32 a10, 0
    v_accvgpr_write_b32 a11, 0
    s_xor_b32 s80, s69, 3
    s_mul_i32 s80, s80, 12288
    ds_read_b64_tr_b16 v[92:93], v11 offset:2048
    ds_read_b64_tr_b16 v[94:95], v11 offset:2560
    s_waitcnt lgkmcnt(12)
    v_mfma_f32_32x32x16_bf16 v[32:47], v[68:71], a[68:71], v[32:47]
    v_mfma_f32_32x32x16_bf16 v[48:63], v[68:71], v[96:99], v[48:63]
    v_accvgpr_write_b32 a12, 0
    v_accvgpr_write_b32 a13, 0
    v_accvgpr_write_b32 a14, 0
    v_accvgpr_write_b32 a15, 0
    s_add_u32 s80, s80, 57344
    v_add_u32 v127, s80, v1
    ds_read_b64_tr_b16 v[64:65], v11 offset:4096
    ds_read_b64_tr_b16 v[66:67], v11 offset:4608
    s_waitcnt lgkmcnt(12)
    v_mfma_f32_32x32x16_bf16 v[32:47], v[72:75], a[72:75], v[32:47]
    v_mfma_f32_32x32x16_bf16 v[48:63], v[72:75], v[96:99], v[48:63]
    v_accvgpr_write_b32 a16, 0
    v_accvgpr_write_b32 a17, 0
    v_accvgpr_write_b32 a18, 0
    v_accvgpr_write_b32 a19, 0
    v_mov_b32 v16, 0
    ds_read_b64_tr_b16 v[68:69], v11 offset:6144
    ds_read_b64_tr_b16 v[70:71], v11 offset:6656
    s_waitcnt lgkmcnt(12)
    v_mfma_f32_32x32x16_bf16 v[32:47], v[76:79], a[76:79], v[32:47]
    v_mfma_f32_32x32x16_bf16 v[48:63], v[76:79], v[96:99], v[48:63]
    v_accvgpr_write_b32 a20, 0
    v_accvgpr_write_b32 a21, 0
    v_accvgpr_write_b32 a22, 0
    v_accvgpr_write_b32 a23, 0
    v_mov_b32 v17, 0
    v_mov_b32 v18, 0
    ds_read_b64_tr_b16 v[72:73], v11 offset:8192
    ds_read_b64_tr_b16 v[74:75], v11 offset:8704
    s_waitcnt lgkmcnt(12)
    v_mfma_f32_32x32x16_bf16 v[32:47], v[80:83], a[80:83], v[32:47]
    v_mfma_f32_32x32x16_bf16 v[48:63], v[80:83], v[96:99], v[48:63]
    v_accvgpr_write_b32 a24, 0
    v_accvgpr_write_b32 a25, 0
    v_accvgpr_write_b32 a26, 0
    v_accvgpr_write_b32 a27, 0
    v_mov_b32 v19, 0
    v_mov_b32 v20, 0
    ds_read_b64_tr_b16 v[76:77], v11 offset:10240
    ds_read_b64_tr_b16 v[78:79], v11 offset:10752
    s_waitcnt lgkmcnt(12)
    v_mfma_f32_32x32x16_bf16 v[32:47], v[84:87], a[84:87], v[32:47]
    v_mfma_f32_32x32x16_bf16 v[48:63], v[84:87], v[96:99], v[48:63]
    v_accvgpr_write_b32 a28, 0
    v_accvgpr_write_b32 a29, 0
    v_accvgpr_write_b32 a30, 0
    v_accvgpr_write_b32 a31, 0
    v_mov_b32 v21, 0
    v_mov_b32 v22, 0
    s_waitcnt lgkmcnt(10)
    v_mfma_f32_32x32x16_bf16 v[32:47], v[88:91], a[88:91], v[32:47]
    v_mfma_f32_32x32x16_bf16 v[48:63], v[88:91], v[96:99], v[48:63]
    v_accvgpr_write_b32 a32, 0
    v_accvgpr_write_b32 a33, 0
    v_accvgpr_write_b32 a34, 0
    v_accvgpr_write_b32 a35, 0
    v_mov_b32 v23, 0
    v_mov_b32 v24, 0
    s_waitcnt lgkmcnt(8)
    v_mfma_f32_32x32x16_bf16 v[32:47], v[92:95], a[92:95], v[32:47]
    v_mfma_f32_32x32x16_bf16 v[48:63], v[92:95], v[96:99], v[48:63]
    v_accvgpr_write_b32 a36, 0
    v_accvgpr_write_b32 a37, 0
    v_accvgpr_write_b32 a38, 0
    v_accvgpr_write_b32 a39, 0
    v_mov_b32 v25, 0
    v_mov_b32 v26, 0
    s_waitcnt lgkmcnt(6)
    v_mfma_f32_32x32x16_bf16 v[32:47], v[64:67], a[96:99], v[32:47]
    v_mfma_f32_32x32x16_bf16 v[48:63], v[64:67], v[96:99], v[48:63]
    v_accvgpr_write_b32 a40, 0
    v_accvgpr_write_b32 a41, 0
    v_accvgpr_write_b32 a42, 0
    v_accvgpr_write_b32 a43, 0
    v_mov_b32 v27, 0
    v_mov_b32 v28, 0
    s_waitcnt lgkmcnt(4)
    v_mfma_f32_32x32x16_bf16 v[32:47], v[68:71], a[100:103], v[32:47]
    v_mfma_f32_32x32x16_bf16 v[48:63], v[68:71], v[96:99], v[48:63]
    v_accvgpr_write_b32 a44, 0
    v_accvgpr_write_b32 a45, 0
    v_accvgpr_write_b32 a46, 0
    v_accvgpr_write_b32 a47, 0
    v_mov_b32 v29, 0
    v_mov_b32 v30, 0
    s_waitcnt lgkmcnt(2)
    v_mfma_f32_32x32x16_bf16 v[32:47], v[72:75], a[104:107], v[32:47]
    v_mfma_f32_32x32x16_bf16 v[48:63], v[72:75], v[96:99], v[48:63]
    v_mov_b32 v31, 0
    v_xor_b32 v109, 2048, v12
    s_waitcnt lgkmcnt(0)
    v_mfma_f32_32x32x16_bf16 v[32:47], v[76:79], a[108:111], v[32:47]
    v_mfma_f32_32x32x16_bf16 v[48:63], v[76:79], v[96:99], v[48:63]
    v_xor_b32 v110, 4096, v12
    v_xor_b32 v111, 6144, v12
    s_nop 9
    v_fma_f32 v32, -v48, v8, v32
    v_mul_f32 v32, v32, v9
    v_fma_f32 v33, -v49, v8, v33
    v_mul_f32 v33, v33, v9
    v_fma_f32 v34, -v50, v8, v34
    v_mul_f32 v34, v34, v9
    v_fma_f32 v35, -v51, v8, v35
    v_mul_f32 v35, v35, v9
    v_fma_f32 v36, -v52, v8, v36
    v_mul_f32 v36, v36, v9
    v_fma_f32 v37, -v53, v8, v37
    v_mul_f32 v37, v37, v9
    v_fma_f32 v38, -v54, v8, v38
    v_mul_f32 v38, v38, v9
    v_fma_f32 v39, -v55, v8, v39
    v_mul_f32 v39, v39, v9
    v_fma_f32 v40, -v56, v8, v40
    v_mul_f32 v40, v40, v9
    v_fma_f32 v41, -v57, v8, v41
    v_mul_f32 v41, v41, v9
    v_fma_f32 v42, -v58, v8, v42
    v_mul_f32 v42, v42, v9
    v_fma_f32 v43, -v59, v8, v43
    v_mul_f32 v43, v43, v9
    v_fma_f32 v44, -v60, v8, v44
    v_mul_f32 v44, v44, v9
    v_fma_f32 v45, -v61, v8, v45
    v_mul_f32 v45, v45, v9
    v_fma_f32 v46, -v62, v8, v46
    v_mul_f32 v46, v46, v9
    v_fma_f32 v47, -v63, v8, v47
    v_mul_f32 v47, v47, v9
    s_mov_b64 exec, s[76:77]
    v_mov_b32 v44, 0
    v_mov_b32 v45, 0
    v_mov_b32 v46, 0
    v_mov_b32 v47, 0
    s_mov_b64 exec, -1
    v_cvt_pk_bf16_f32 v48, v32, v33
    v_cvt_pk_bf16_f32 v49, v34, v35
    v_cvt_pk_bf16_f32 v50, v36, v37
    v_cvt_pk_bf16_f32 v51, v38, v39
    v_cvt_pk_bf16_f32 v52, v40, v41
    v_cvt_pk_bf16_f32 v53, v42, v43
    v_cvt_pk_bf16_f32 v54, v44, v45
    v_cvt_pk_bf16_f32 v55, v46, v47
    ds_write_b128 v12, v[48:51]
    ds_write_b128 v12, v[52:55] offset:1024
    v_mul_f32 v56, v32, v32
    v_fma_f32 v56, v33, v33, v56
    v_fma_f32 v56, v34, v34, v56
    v_fma_f32 v56, v35, v35, v56
    v_fma_f32 v56, v36, v36, v56
    v_fma_f32 v56, v37, v37, v56
    v_fma_f32 v56, v38, v38, v56
    v_fma_f32 v56, v39, v39, v56
    v_fma_f32 v56, v40, v40, v56
    v_fma_f32 v56, v41, v41, v56
    v_fma_f32 v56, v42, v42, v56
    v_fma_f32 v56, v43, v43, v56
    v_fma_f32 v56, v44, v44, v56
    v_fma_f32 v56, v45, v45, v56
    v_fma_f32 v56, v46, v46, v56
    v_fma_f32 v56, v47, v47, v56
    v_mov_b32 v57, v56
    s_nop 1
    v_permlane32_swap_b32 v56, v57
    v_add_f32 v56, v56, v57
    ds_write_b32 v15, v56
    s_mov_b64 exec, 1
    v_mov_b32 v4, 159756
    v_mov_b32 v5, 1
    ds_add_u32 v4, v5
    s_mov_b64 exec, -1
    v_mov_b32 v68, 0
    v_mov_b32 v100, 0
    v_mov_b32 v69, 0
    v_mov_b32 v101, 0
    v_mov_b32 v70, 0
    v_mov_b32 v102, 0
    v_mov_b32 v71, 0
    v_mov_b32 v103, 0
    v_mov_b32 v4, 159756
    s_mov_b32 s90, 0
L_ls_63:
    ds_read_b32 v5, v4
    s_add_u32 s90, s90, 1
    s_waitcnt lgkmcnt(0)
    v_readfirstlane_b32 s100, v5
    s_cmp_ge_u32 s100, 4
    s_cbranch_scc1 L_lk_64
    s_cmp_lt_u32 s90, 400000
    s_cbranch_scc1 L_ls_63
L_lk_64:
    ds_read_b128 a[48:51], v12 offset:0
    ds_read_b128 a[52:55], v12 offset:1024
    ds_read_b128 a[56:59], v109 offset:0
    ds_read_b128 a[60:63], v109 offset:1024
    ds_read_b128 a[64:67], v110 offset:0
    ds_read_b128 a[68:71], v110 offset:1024
    ds_read_b128 a[72:75], v111 offset:0
    ds_read_b128 a[76:79], v111 offset:1024
    ds_read_b32 v120, v14 offset:0
    ds_read_b32 v121, v14 offset:256
    ds_read_b32 v122, v14 offset:512
    ds_read_b32 v123, v14 offset:768
    s_waitcnt lgkmcnt(0)
    s_mov_b64 exec, 1
    v_mov_b32 v4, 159760
    v_mov_b32 v5, 1
    ds_add_u32 v4, v5
    s_mov_b64 exec, -1
    s_setprio 3
    s_cmp_lg_u32 s69, 0
    s_cbranch_scc1 L_gw_67
    v_lshlrev_b32 v5, 7, v0
    v_add_u32 v5, 294912, v5
    s_mov_b64 s[78:79], s[76:77]
    s_mov_b64 vcc, s[78:79]
    v_mov_b32 v7, 2147418112
    v_cndmask_b32 v6, v5, v7, vcc
    s_mov_b32 s90, 0
L_gs_65:
    buffer_load_dwordx4 v[112:115], v6, s[16:19], 0 offen sc1
    s_add_u32 s90, s90, 1
    s_waitcnt vmcnt(0)
    v_cmp_eq_u64 vcc, s[66:67], v[112:113]
    s_or_b64 vcc, vcc, s[78:79]
    s_cmp_eq_u64 vcc, -1
    s_cbranch_scc1 L_gk_66
    s_cmp_lt_u32 s90, 20000
    s_cbranch_scc1 L_gs_65
L_gk_66:
    v_mov_b32 v113, 159852
    ds_max_u32 v113, v114
    s_mov_b64 exec, 1
    v_mov_b32 v4, 159844
    v_mov_b32 v5, 1
    ds_add_u32 v4, v5
    s_mov_b64 exec, -1
L_gw_67:
    v_mov_b32 v4, 159844
    s_mov_b32 s90, 0
L_ls_68:
    ds_read_b32 v5, v4
    s_add_u32 s90, s90, 1
    s_waitcnt lgkmcnt(0)
    v_readfirstlane_b32 s100, v5
    s_cmp_ge_u32 s100, 1
    s_cbranch_scc1 L_lk_69
    s_cmp_lt_u32 s90, 400000
    s_cbranch_scc1 L_ls_68
L_lk_69:
    v_mov_b32 v113, 159852
    ds_read_b32 v112, v113
    s_setprio 3
    buffer_load_dwordx4 a[80:83], v104, s[16:19], s91 offen offset:0 sc1
    buffer_load_dwordx4 a[84:87], v104, s[16:19], s91 offen offset:1024 sc1
    buffer_load_dwordx4 v[72:75], v104, s[16:19], s91 offen offset:2048 sc1
    buffer_load_dwordx4 v[76:79], v104, s[16:19], s91 offen offset:3072 sc1
    s_setprio 0
    buffer_load_dwordx4 a[88:91], v105, s[16:19], s91 offen offset:0 sc1
    buffer_load_dwordx4 a[92:95], v105, s[16:19], s91 offen offset:1024 sc1
    buffer_load_dwordx4 v[80:83], v105, s[16:19], s91 offen offset:2048 sc1
    buffer_load_dwordx4 v[84:87], v105, s[16:19], s91 offen offset:3072 sc1
    buffer_load_dwordx4 a[96:99], v106, s[16:19], s91 offen offset:0 sc1
    buffer_load_dwordx4 a[100:103], v106, s[16:19], s91 offen offset:1024 sc1
    buffer_load_dwordx4 v[88:91], v106, s[16:19], s91 offen offset:2048 sc1
    buffer_load_dwordx4 v[92:95], v106, s[16:19], s91 offen offset:3072 sc1
    buffer_load_dwordx4 a[104:107], v107, s[16:19], s91 offen offset:0 sc1
    buffer_load_dwordx4 a[108:111], v107, s[16:19], s91 offen offset:1024 sc1
    s_waitcnt lgkmcnt(0)
    v_max3_f32 v120, v120, v121, v122
    v_max_f32 v120, v120, v123
    v_mul_f32 v108, v112, v120
    v_cmp_nge_f32 vcc, 0x455ac000, v108
    s_cmp_lg_u64 vcc, 0
    s_cbranch_scc1 L_slow
L_fast:
    s_waitcnt vmcnt(10)
    v_mfma_f32_32x32x16_bf16 v[32:47], a[80:83], a[48:51], 0
    v_mfma_f32_32x32x16_bf16 v[32:47], a[84:87], a[52:55], v[32:47]
    s_mov_b32 s84, 4
    s_nop 7
    s_nop 1
L_aloop:
    v_mfma_f32_32x32x16_bf16 v[48:63], a[80:83], a[56:59], 0
    v_exp_f32 v32, v32
    v_exp_f32 v33, v33
    v_exp_f32 v34, v34
    v_exp_f32 v35, v35
    v_mfma_f32_32x32x16_bf16 a[32:47], v[100:103], v[68:71], a[32:47]
    v_cvt_pk_bf16_f32 v64, v32, v33
    v_cvt_pk_bf16_f32 v65, v34, v35
    v_exp_f32 v36, v36
    v_exp_f32 v37, v37
    v_exp_f32 v38, v38
    v_exp_f32 v39, v39
    v_mfma_f32_32x32x16_bf16 v[48:63], a[84:87], a[60:63], v[48:63]
    v_cvt_pk_bf16_f32 v66, v36, v37
    v_cvt_pk_bf16_f32 v67, v38, v39
    v_exp_f32 v40, v40
    v_exp_f32 v41, v41
    v_exp_f32 v42, v42
    v_exp_f32 v43, v43
    v_mfma_f32_32x32x16_bf16 v[16:31], v[72:75], v[64:67], v[16:31]
    v_cvt_pk_bf16_f32 v68, v40, v41
    v_cvt_pk_bf16_f32 v69, v42, v43
    v_exp_f32 v44, v44
    v_exp_f32 v45, v45
    v_exp_f32 v46, v46
    v_exp_f32 v47, v47
    v_cvt_pk_bf16_f32 v70, v44, v45
    v_cvt_pk_bf16_f32 v71, v46, v47
    v_mfma_f32_32x32x16_bf16 v[32:47], a[80:83], a[64:67], 0
    v_exp_f32 v48, v48
    v_exp_f32 v49, v49
    v_exp_f32 v50, v50
    v_exp_f32 v51, v51
    v_mfma_f32_32x32x16_bf16 v[16:31], v[76:79], v[68:71], v[16:31]
    v_cvt_pk_bf16_f32 v64, v48, v49
    v_cvt_pk_bf16_f32 v65, v50, v51
    v_exp_f32 v52, v52
    v_exp_f32 v53, v53
    v_exp_f32 v54, v54
    v_exp_f32 v55, v55
    v_mfma_f32_32x32x16_bf16 v[32:47], a[84:87], a[68:71], v[32:47]
    v_cvt_pk_bf16_f32 v66, v52, v53
    v_cvt_pk_bf16_f32 v67, v54, v55
    v_exp_f32 v56, v56
    v_exp_f32 v57, v57
    v_exp_f32 v58, v58
    v_exp_f32 v59, v59
    v_mfma_f32_32x32x16_bf16 a[0:15], v[72:75], v[64:67], a[0:15]
    v_cvt_pk_bf16_f32 v68, v56, v57
    v_cvt_pk_bf16_f32 v69, v58, v59
    v_exp_f32 v60, v60
    v_exp_f32 v61, v61
    v_exp_f32 v62, v62
    v_exp_f32 v63, v63
    v_cvt_pk_bf16_f32 v70, v60, v61
    v_cvt_pk_bf16_f32 v71, v62, v63
    v_mfma_f32_32x32x16_bf16 v[48:63], a[80:83], a[72:75], 0
    v_exp_f32 v32, v32
    v_exp_f32 v33, v33
    v_exp_f32 v34, v34
    v_exp_f32 v35, v35
    v_mfma_f32_32x32x16_bf16 a[0:15], v[76:79], v[68:71], a[0:15]
    v_cvt_pk_bf16_f32 v64, v32, v33
    v_cvt_pk_bf16_f32 v65, v34, v35
    v_exp_f32 v36, v36
    v_exp_f32 v37, v37
    v_exp_f32 v38, v38
    v_exp_f32 v39, v39
    v_mfma_f32_32x32x16_bf16 v[48:63], a[84:87], a[76:79], v[48:63]
    v_cvt_pk_bf16_f32 v66, v36, v37
    v_cvt_pk_bf16_f32 v67, v38, v39
    v_exp_f32 v40, v40
    v_exp_f32 v41, v41
    v_exp_f32 v42, v42
    v_exp_f32 v43, v43
    v_mfma_f32_32x32x16_bf16 a[16:31], v[72:75], v[64:67], a[16:31]
    v_cvt_pk_bf16_f32 v68, v40, v41
    v_cvt_pk_bf16_f32 v69, v42, v43
    v_exp_f32 v44, v44
    v_exp_f32 v45, v45
    v_exp_f32 v46, v46
    v_exp_f32 v47, v47
    v_cvt_pk_bf16_f32 v70, v44, v45
    v_cvt_pk_bf16_f32 v71, v46, v47
    s_waitcnt vmcnt(6)
    v_mfma_f32_32x32x16_bf16 v[32:47], a[88:91], a[48:51], 0
    s_setprio 3
    buffer_load_dwordx4 v[96:99], v107, s[16:19], s91 offen offset:2048 sc1
    buffer_load_dwordx4 v[100:103], v107, s[16:19], s91 offen offset:3072 sc1
    buffer_load_dwordx4 a[80:83], v104, s[16:19], s92 offen offset:0 sc1
    buffer_load_dwordx4 a[84:87], v104, s[16:19], s92 offen offset:1024 sc1
    s_setprio 0
    v_exp_f32 v48, v48
    v_exp_f32 v49, v49
    v_exp_f32 v50, v50
    v_exp_f32 v51, v51
    v_mfma_f32_32x32x16_bf16 a[16:31], v[76:79], v[68:71], a[16:31]
    v_cvt_pk_bf16_f32 v64, v48, v49
    v_cvt_pk_bf16_f32 v65, v50, v51
    v_exp_f32 v52, v52
    v_exp_f32 v53, v53
    v_exp_f32 v54, v54
    v_exp_f32 v55, v55
    v_mfma_f32_32x32x16_bf16 v[32:47], a[92:95], a[52:55], v[32:47]
    v_cvt_pk_bf16_f32 v66, v52, v53
    v_cvt_pk_bf16_f32 v67, v54, v55
    v_exp_f32 v56, v56
    v_exp_f32 v57, v57
    v_exp_f32 v58, v58
    v_exp_f32 v59, v59
    v_mfma_f32_32x32x16_bf16 a[32:47], v[72:75], v[64:67], a[32:47]
    v_cvt_pk_bf16_f32 v68, v56, v57
    v_cvt_pk_bf16_f32 v69, v58, v59
    v_exp_f32 v60, v60
    v_exp_f32 v61, v61
    v_exp_f32 v62, v62
    v_exp_f32 v63, v63
    v_cvt_pk_bf16_f32 v70, v60, v61
    v_cvt_pk_bf16_f32 v71, v62, v63
    v_mfma_f32_32x32x16_bf16 v[48:63], a[88:91], a[56:59], 0
    v_exp_f32 v32, v32
    v_exp_f32 v33, v33
    v_exp_f32 v34, v34
    v_exp_f32 v35, v35
    v_mfma_f32_32x32x16_bf16 a[32:47], v[76:79], v[68:71], a[32:47]
    v_cvt_pk_bf16_f32 v64, v32, v33
    v_cvt_pk_bf16_f32 v65, v34, v35
    v_exp_f32 v36, v36
    v_exp_f32 v37, v37
    v_exp_f32 v38, v38
    v_exp_f32 v39, v39
    v_mfma_f32_32x32x16_bf16 v[48:63], a[92:95], a[60:63], v[48:63]
    v_cvt_pk_bf16_f32 v66, v36, v37
    v_cvt_pk_bf16_f32 v67, v38, v39
    v_exp_f32 v40, v40
    v_exp_f32 v41, v41
    v_exp_f32 v42, v42
    v_exp_f32 v43, v43
    v_mfma_f32_32x32x16_bf16 v[16:31], v[80:83], v[64:67], v[16:31]
    v_cvt_pk_bf16_f32 v68, v40, v41
    v_cvt_pk_bf16_f32 v69, v42, v43
    v_exp_f32 v44, v44
    v_exp_f32 v45, v45
    v_exp_f32 v46, v46
    v_exp_f32 v47, v47
    v_cvt_pk_bf16_f32 v70, v44, v45
    v_cvt_pk_bf16_f32 v71, v46, v47
    v_mfma_f32_32x32x16_bf16 v[32:47], a[88:91], a[64:67], 0
    v_exp_f32 v48, v48
    v_exp_f32 v49, v49
    v_exp_f32 v50, v50
    v_exp_f32 v51, v51
    v_mfma_f32_32x32x16_bf16 v[16:31], v[84:87], v[68:71], v[16:31]
    v_cvt_pk_bf16_f32 v64, v48, v49
    v_cvt_pk_bf16_f32 v65, v50, v51
    v_exp_f32 v52, v52
    v_exp_f32 v53, v53
    v_exp_f32 v54, v54
    v_exp_f32 v55, v55
    v_mfma_f32_32x32x16_bf16 v[32:47], a[92:95], a[68:71], v[32:47]
    v_cvt_pk_bf16_f32 v66, v52, v53
    v_cvt_pk_bf16_f32 v67, v54, v55
    v_exp_f32 v56, v56
    v_exp_f32 v57, v57
    v_exp_f32 v58, v58
    v_exp_f32 v59, v59
    v_mfma_f32_32x32x16_bf16 a[0:15], v[80:83], v[64:67], a[0:15]
    v_cvt_pk_bf16_f32 v68, v56, v57
    v_cvt_pk_bf16_f32 v69, v58, v59
    v_exp_f32 v60, v60
    v_exp_f32 v61, v61
    v_exp_f32 v62, v62
    v_exp_f32 v63, v63
    v_cvt_pk_bf16_f32 v70, v60, v61
    v_cvt_pk_bf16_f32 v71, v62, v63
    v_mfma_f32_32x32x16_bf16 v[48:63], a[88:91], a[72:75], 0
    v_exp_f32 v32, v32
    v_exp_f32 v33, v33
    v_exp_f32 v34, v34
    v_exp_f32 v35, v35
    v_mfma_f32_32x32x16_bf16 a[0:15], v[84:87], v[68:71], a[0:15]
    v_cvt_pk_bf16_f32 v64, v32, v33
    v_cvt_pk_bf16_f32 v65, v34, v35
    v_exp_f32 v36, v36
    v_exp_f32 v37, v37
    v_exp_f32 v38, v38
    v_exp_f32 v39, v39
    v_mfma_f32_32x32x16_bf16 v[48:63], a[92:95], a[76:79], v[48:63]
    v_cvt_pk_bf16_f32 v66, v36, v37
    v_cvt_pk_bf16_f32 v67, v38, v39
    v_exp_f32 v40, v40
    v_exp_f32 v41, v41
    v_exp_f32 v42, v42
    v_exp_f32 v43, v43
    v_mfma_f32_32x32x16_bf16 a[16:31], v[80:83], v[64:67], a[16:31]
    v_cvt_pk_bf16_f32 v68, v40, v41
    v_cvt_pk_bf16_f32 v69, v42, v43
    v_exp_f32 v44, v44
    v_exp_f32 v45, v45
    v_exp_f32 v46, v46
    v_exp_f32 v47, v47
    v_cvt_pk_bf16_f32 v70, v44, v45
    v_cvt_pk_bf16_f32 v71, v46, v47
    s_waitcnt vmcnt(6)
    v_mfma_f32_32x32x16_bf16 v[32:47], a[96:99], a[48:51], 0
    s_setprio 3
    buffer_load_dwordx4 v[72:75], v104, s[16:19], s92 offen offset:2048 sc1
    buffer_load_dwordx4 v[76:79], v104, s[16:19], s92 offen offset:3072 sc1
    buffer_load_dwordx4 a[88:91], v105, s[16:19], s92 offen offset:0 sc1
    buffer_load_dwordx4 a[92:95], v105, s[16:19], s92 offen offset:1024 sc1
    s_setprio 0
    v_exp_f32 v48, v48
    v_exp_f32 v49, v49
    v_exp_f32 v50, v50
    v_exp_f32 v51, v51
    v_mfma_f32_32x32x16_bf16 a[16:31], v[84:87], v[68:71], a[16:31]
    v_cvt_pk_bf16_f32 v64, v48, v49
    v_cvt_pk_bf16_f32 v65, v50, v51
    v_exp_f32 v52, v52
    v_exp_f32 v53, v53
    v_exp_f32 v54, v54
    v_exp_f32 v55, v55
    v_mfma_f32_32x32x16_bf16 v[32:47], a[100:103], a[52:55], v[32:47]
    v_cvt_pk_bf16_f32 v66, v52, v53
    v_cvt_pk_bf16_f32 v67, v54, v55
    v_exp_f32 v56, v56
    v_exp_f32 v57, v57
    v_exp_f32 v58, v58
    v_exp_f32 v59, v59
    v_mfma_f32_32x32x16_bf16 a[32:47], v[80:83], v[64:67], a[32:47]
    v_cvt_pk_bf16_f32 v68, v56, v57
    v_cvt_pk_bf16_f32 v69, v58, v59
    v_exp_f32 v60, v60
    v_exp_f32 v61, v61
    v_exp_f32 v62, v62
    v_exp_f32 v63, v63
    v_cvt_pk_bf16_f32 v70, v60, v61
    v_cvt_pk_bf16_f32 v71, v62, v63
    v_mfma_f32_32x32x16_bf16 v[48:63], a[96:99], a[56:59], 0
    v_exp_f32 v32, v32
    v_exp_f32 v33, v33
    v_exp_f32 v34, v34
    v_exp_f32 v35, v35
    v_mfma_f32_32x32x16_bf16 a[32:47], v[84:87], v[68:71], a[32:47]
    v_cvt_pk_bf16_f32 v64, v32, v33
    v_cvt_pk_bf16_f32 v65, v34, v35
    v_exp_f32 v36, v36
    v_exp_f32 v37, v37
    v_exp_f32 v38, v38
    v_exp_f32 v39, v39
    v_mfma_f32_32x32x16_bf16 v[48:63], a[100:103], a[60:63], v[48:63]
    v_cvt_pk_bf16_f32 v66, v36, v37
    v_cvt_pk_bf16_f32 v67, v38, v39
    v_exp_f32 v40, v40
    v_exp_f32 v41, v41
    v_exp_f32 v42, v42
    v_exp_f32 v43, v43
    v_mfma_f32_32x32x16_bf16 v[16:31], v[88:91], v[64:67], v[16:31]
    v_cvt_pk_bf16_f32 v68, v40, v41
    v_cvt_pk_bf16_f32 v69, v42, v43
    v_exp_f32 v44, v44
    v_exp_f32 v45, v45
    v_exp_f32 v46, v46
    v_exp_f32 v47, v47
    v_cvt_pk_bf16_f32 v70, v44, v45
    v_cvt_pk_bf16_f32 v71, v46, v47
    v_mfma_f32_32x32x16_bf16 v[32:47], a[96:99], a[64:67], 0
    v_exp_f32 v48, v48
    v_exp_f32 v49, v49
    v_exp_f32 v50, v50
    v_exp_f32 v51, v51
    v_mfma_f32_32x32x16_bf16 v[16:31], v[92:95], v[68:71], v[16:31]
    v_cvt_pk_bf16_f32 v64, v48, v49
    v_cvt_pk_bf16_f32 v65, v50, v51
    v_exp_f32 v52, v52
    v_exp_f32 v53, v53
    v_exp_f32 v54, v54
    v_exp_f32 v55, v55
    v_mfma_f32_32x32x16_bf16 v[32:47], a[100:103], a[68:71], v[32:47]
    v_cvt_pk_bf16_f32 v66, v52, v53
    v_cvt_pk_bf16_f32 v67, v54, v55
    v_exp_f32 v56, v56
    v_exp_f32 v57, v57
    v_exp_f32 v58, v58
    v_exp_f32 v59, v59
    v_mfma_f32_32x32x16_bf16 a[0:15], v[88:91], v[64:67], a[0:15]
    v_cvt_pk_bf16_f32 v68, v56, v57
    v_cvt_pk_bf16_f32 v69, v58, v59
    v_exp_f32 v60, v60
    v_exp_f32 v61, v61
    v_exp_f32 v62, v62
    v_exp_f32 v63, v63
    v_cvt_pk_bf16_f32 v70, v60, v61
    v_cvt_pk_bf16_f32 v71, v62, v63
    v_mfma_f32_32x32x16_bf16 v[48:63], a[96:99], a[72:75], 0
    v_exp_f32 v32, v32
    v_exp_f32 v33, v33
    v_exp_f32 v34, v34
    v_exp_f32 v35, v35
    v_mfma_f32_32x32x16_bf16 a[0:15], v[92:95], v[68:71], a[0:15]
    v_cvt_pk_bf16_f32 v64, v32, v33
    v_cvt_pk_bf16_f32 v65, v34, v35
    v_exp_f32 v36, v36
    v_exp_f32 v37, v37
    v_exp_f32 v38, v38
    v_exp_f32 v39, v39
    v_mfma_f32_32x32x16_bf16 v[48:63], a[100:103], a[76:79], v[48:63]
    v_cvt_pk_bf16_f32 v66, v36, v37
    v_cvt_pk_bf16_f32 v67, v38, v39
    v_exp_f32 v40, v40
    v_exp_f32 v41, v41
    v_exp_f32 v42, v42
    v_exp_f32 v43, v43
    v_mfma_f32_32x32x16_bf16 a[16:31], v[88:91], v[64:67], a[16:31]
    v_cvt_pk_bf16_f32 v68, v40, v41
    v_cvt_pk_bf16_f32 v69, v42, v43
    v_exp_f32 v44, v44
    v_exp_f32 v45, v45
    v_exp_f32 v46, v46
    v_exp_f32 v47, v47
    v_cvt_pk_bf16_f32 v70, v44, v45
    v_cvt_pk_bf16_f32 v71, v46, v47
    s_waitcnt vmcnt(6)
    v_mfma_f32_32x32x16_bf16 v[32:47], a[104:107], a[48:51], 0
    s_setprio 3
    buffer_load_dwordx4 v[80:83], v105, s[16:19], s92 offen offset:2048 sc1
    buffer_load_dwordx4 v[84:87], v105, s[16:19], s92 offen offset:3072 sc1
    buffer_load_dwordx4 a[96:99], v106, s[16:19], s92 offen offset:0 sc1
    buffer_load_dwordx4 a[100:103], v106, s[16:19], s92 offen offset:1024 sc1
    s_setprio 0
    v_exp_f32 v48, v48
    v_exp_f32 v49, v49
    v_exp_f32 v50, v50
    v_exp_f32 v51, v51
    v_mfma_f32_32x32x16_bf16 a[16:31], v[92:95], v[68:71], a[16:31]
    v_cvt_pk_bf16_f32 v64, v48, v49
    v_cvt_pk_bf16_f32 v65, v50, v51
    v_exp_f32 v52, v52
    v_exp_f32 v53, v53
    v_exp_f32 v54, v54
    v_exp_f32 v55, v55
    v_mfma_f32_32x32x16_bf16 v[32:47], a[108:111], a[52:55], v[32:47]
    v_cvt_pk_bf16_f32 v66, v52, v53
    v_cvt_pk_bf16_f32 v67, v54, v55
    v_exp_f32 v56, v56
    v_exp_f32 v57, v57
    v_exp_f32 v58, v58
    v_exp_f32 v59, v59
    v_mfma_f32_32x32x16_bf16 a[32:47], v[88:91], v[64:67], a[32:47]
    v_cvt_pk_bf16_f32 v68, v56, v57
    v_cvt_pk_bf16_f32 v69, v58, v59
    v_exp_f32 v60, v60
    v_exp_f32 v61, v61
    v_exp_f32 v62, v62
    v_exp_f32 v63, v63
    v_cvt_pk_bf16_f32 v70, v60, v61
    v_cvt_pk_bf16_f32 v71, v62, v63
    v_mfma_f32_32x32x16_bf16 v[48:63], a[104:107], a[56:59], 0
    v_exp_f32 v32, v32
    v_exp_f32 v33, v33
    v_exp_f32 v34, v34
    v_exp_f32 v35, v35
    v_mfma_f32_32x32x16_bf16 a[32:47], v[92:95], v[68:71], a[32:47]
    v_cvt_pk_bf16_f32 v64, v32, v33
    v_cvt_pk_bf16_f32 v65, v34, v35
    v_exp_f32 v36, v36
    v_exp_f32 v37, v37
    v_exp_f32 v38, v38
    v_exp_f32 v39, v39
    v_mfma_f32_32x32x16_bf16 v[48:63], a[108:111], a[60:63], v[48:63]
    v_cvt_pk_bf16_f32 v66, v36, v37
    v_cvt_pk_bf16_f32 v67, v38, v39
    v_exp_f32 v40, v40
    v_exp_f32 v41, v41
    v_exp_f32 v42, v42
    v_exp_f32 v43, v43
    v_mfma_f32_32x32x16_bf16 v[16:31], v[96:99], v[64:67], v[16:31]
    v_cvt_pk_bf16_f32 v68, v40, v41
    v_cvt_pk_bf16_f32 v69, v42, v43
    v_exp_f32 v44, v44
    v_exp_f32 v45, v45
    v_exp_f32 v46, v46
    v_exp_f32 v47, v47
    v_cvt_pk_bf16_f32 v70, v44, v45
    v_cvt_pk_bf16_f32 v71, v46, v47
    v_mfma_f32_32x32x16_bf16 v[32:47], a[104:107], a[64:67], 0
    v_exp_f32 v48, v48
    v_exp_f32 v49, v49
    v_exp_f32 v50, v50
    v_exp_f32 v51, v51
    v_mfma_f32_32x32x16_bf16 v[16:31], v[100:103], v[68:71], v[16:31]
    v_cvt_pk_bf16_f32 v64, v48, v49
    v_cvt_pk_bf16_f32 v65, v50, v51
    v_exp_f32 v52, v52
    v_exp_f32 v53, v53
    v_exp_f32 v54, v54
    v_exp_f32 v55, v55
    v_mfma_f32_32x32x16_bf16 v[32:47], a[108:111], a[68:71], v[32:47]
    v_cvt_pk_bf16_f32 v66, v52, v53
    v_cvt_pk_bf16_f32 v67, v54, v55
    v_exp_f32 v56, v56
    v_exp_f32 v57, v57
    v_exp_f32 v58, v58
    v_exp_f32 v59, v59
    v_mfma_f32_32x32x16_bf16 a[0:15], v[96:99], v[64:67], a[0:15]
    v_cvt_pk_bf16_f32 v68, v56, v57
    v_cvt_pk_bf16_f32 v69, v58, v59
    v_exp_f32 v60, v60
    v_exp_f32 v61, v61
    v_exp_f32 v62, v62
    v_exp_f32 v63, v63
    v_cvt_pk_bf16_f32 v70, v60, v61
    v_cvt_pk_bf16_f32 v71, v62, v63
    v_mfma_f32_32x32x16_bf16 v[48:63], a[104:107], a[72:75], 0
    v_exp_f32 v32, v32
    v_exp_f32 v33, v33
    v_exp_f32 v34, v34
    v_exp_f32 v35, v35
    v_mfma_f32_32x32x16_bf16 a[0:15], v[100:103], v[68:71], a[0:15]
    v_cvt_pk_bf16_f32 v64, v32, v33
    v_cvt_pk_bf16_f32 v65, v34, v35
    v_exp_f32 v36, v36
    v_exp_f32 v37, v37
    v_exp_f32 v38, v38
    v_exp_f32 v39, v39
    v_mfma_f32_32x32x16_bf16 v[48:63], a[108:111], a[76:79], v[48:63]
    v_cvt_pk_bf16_f32 v66, v36, v37
    v_cvt_pk_bf16_f32 v67, v38, v39
    v_exp_f32 v40, v40
    v_exp_f32 v41, v41
    v_exp_f32 v42, v42
    v_exp_f32 v43, v43
    v_mfma_f32_32x32x16_bf16 a[16:31], v[96:99], v[64:67], a[16:31]
    v_cvt_pk_bf16_f32 v68, v40, v41
    v_cvt_pk_bf16_f32 v69, v42, v43
    v_exp_f32 v44, v44
    v_exp_f32 v45, v45
    v_exp_f32 v46, v46
    v_exp_f32 v47, v47
    v_cvt_pk_bf16_f32 v70, v44, v45
    v_cvt_pk_bf16_f32 v71, v46, v47
    s_waitcnt vmcnt(6)
    v_mfma_f32_32x32x16_bf16 v[32:47], a[80:83], a[48:51], 0
    s_setprio 3
    buffer_load_dwordx4 v[88:91], v106, s[16:19], s92 offen offset:2048 sc1
    buffer_load_dwordx4 v[92:95], v106, s[16:19], s92 offen offset:3072 sc1
    buffer_load_dwordx4 a[104:107], v107, s[16:19], s92 offen offset:0 sc1
    buffer_load_dwordx4 a[108:111], v107, s[16:19], s92 offen offset:1024 sc1
    s_setprio 0
    v_exp_f32 v48, v48
    v_exp_f32 v49, v49
    v_exp_f32 v50, v50
    v_exp_f32 v51, v51
    v_mfma_f32_32x32x16_bf16 a[16:31], v[100:103], v[68:71], a[16:31]
    v_cvt_pk_bf16_f32 v64, v48, v49
    v_cvt_pk_bf16_f32 v65, v50, v51
    v_exp_f32 v52, v52
    v_exp_f32 v53, v53
    v_exp_f32 v54, v54
    v_exp_f32 v55, v55
    v_mfma_f32_32x32x16_bf16 v[32:47], a[84:87], a[52:55], v[32:47]
    v_cvt_pk_bf16_f32 v66, v52, v53
    v_cvt_pk_bf16_f32 v67, v54, v55
    v_exp_f32 v56, v56
    v_exp_f32 v57, v57
    v_exp_f32 v58, v58
    v_exp_f32 v59, v59
    v_mfma_f32_32x32x16_bf16 a[32:47], v[96:99], v[64:67], a[32:47]
    v_cvt_pk_bf16_f32 v68, v56, v57
    v_cvt_pk_bf16_f32 v69, v58, v59
    v_exp_f32 v60, v60
    v_exp_f32 v61, v61
    v_exp_f32 v62, v62
    v_exp_f32 v63, v63
    v_cvt_pk_bf16_f32 v70, v60, v61
    v_cvt_pk_bf16_f32 v71, v62, v63
    s_mov_b32 s91, s92
    s_add_u32 s92, s92, 0x4000
    s_and_b32 s92, s92, 0xffff
    s_cmp_eq_u32 s84, 2
    s_cselect_b32 s92, 2147418112, s92
    s_sub_u32 s84, s84, 1
    s_cmp_lg_u32 s84, 0
    s_cbranch_scc1 L_aloop
    v_mfma_f32_32x32x16_bf16 a[32:47], v[100:103], v[68:71], a[32:47]
    s_setprio 3
    v_mov_b32 v4, 159784
    ds_read_b32 v5, v4
    ds_read_b32 v6, v4 offset:72
    s_waitcnt lgkmcnt(0)
    v_readfirstlane_b32 s80, v5
    v_readfirstlane_b32 s3, v6
    s_cmp_ge_u32 s80, 4
    s_cbranch_scc1 L_free
    v_mov_b32 v4, 159784
    s_mov_b32 s90, 0
L_ls_70:
    ds_read_b32 v5, v4
    s_add_u32 s90, s90, 1
    s_waitcnt lgkmcnt(0)
    v_readfirstlane_b32 s100, v5
    s_cmp_ge_u32 s100, 4
    s_cbranch_scc1 L_lk_71
    s_cmp_lt_u32 s90, 400000
    s_cbranch_scc1 L_ls_70
L_lk_71:
    v_mov_b32 v4, 159856
    ds_read_b32 v5, v4
    s_waitcnt lgkmcnt(0)
    v_readfirstlane_b32 s3, v5
L_free:
    s_nop 2
    ds_write_b128 v124, a[0:3] offset:0
    ds_write_b128 v124, a[4:7] offset:1024
    ds_write_b128 v124, a[8:11] offset:2048
    ds_write_b128 v124, a[12:15] offset:3072
    ds_write_b128 v124, a[16:19] offset:4096
    ds_write_b128 v124, a[20:23] offset:5120
    ds_write_b128 v124, a[24:27] offset:6144
    ds_write_b128 v124, a[28:31] offset:7168
    ds_write_b128 v124, a[32:35] offset:8192
    ds_write_b128 v124, a[36:39] offset:9216
    ds_write_b128 v124, a[40:43] offset:10240
    ds_write_b128 v124, a[44:47] offset:11264
    s_mov_b64 exec, 1
    v_mov_b32 v4, 159768
    v_mov_b32 v5, 1
    ds_add_u32 v4, v5
    s_mov_b64 exec, -1
    v_mov_b32 v4, 159768
    s_mov_b32 s90, 0
L_ls_72:
    ds_read_b32 v5, v4
    s_add_u32 s90, s90, 1
    s_waitcnt lgkmcnt(0)
    v_readfirstlane_b32 s100, v5
    s_cmp_ge_u32 s100, 4
    s_cbranch_scc1 L_lk_73
    s_cmp_lt_u32 s90, 400000
    s_cbranch_scc1 L_ls_72
L_lk_73:
    ds_read_b128 v[32:35], v125 offset:0
    ds_read_b128 v[36:39], v125 offset:1024
    ds_read_b128 v[40:43], v125 offset:2048
    ds_read_b128 v[44:47], v125 offset:3072
    ds_read_b128 v[48:51], v126 offset:4096
    ds_read_b128 v[52:55], v126 offset:5120
    ds_read_b128 v[56:59], v126 offset:6144
    ds_read_b128 v[60:63], v126 offset:7168
    ds_read_b128 v[104:107], v127 offset:8192
    ds_read_b128 v[108:111], v127 offset:9216
    ds_read_b128 v[112:115], v127 offset:10240
    ds_read_b128 v[116:119], v127 offset:11264
    s_waitcnt lgkmcnt(8)
    v_add_f32 v16, v16, v32
    v_add_f32 v17, v17, v33
    v_add_f32 v18, v18, v34
    v_add_f32 v19, v19, v35
    v_add_f32 v20, v20, v36
    v_add_f32 v21, v21, v37
    v_add_f32 v22, v22, v38
    v_add_f32 v23, v23, v39
    v_add_f32 v24, v24, v40
    v_add_f32 v25, v25, v41
    v_add_f32 v26, v26, v42
    v_add_f32 v27, v27, v43
    v_add_f32 v28, v28, v44
    v_add_f32 v29, v29, v45
    v_add_f32 v30, v30, v46
    v_add_f32 v31, v31, v47
    s_waitcnt lgkmcnt(4)
    v_add_f32 v16, v16, v48
    v_add_f32 v17, v17, v49
    v_add_f32 v18, v18, v50
    v_add_f32 v19, v19, v51
    v_add_f32 v20, v20, v52
    v_add_f32 v21, v21, v53
    v_add_f32 v22, v22, v54
    v_add_f32 v23, v23, v55
    v_add_f32 v24, v24, v56
    v_add_f32 v25, v25, v57
    v_add_f32 v26, v26, v58
    v_add_f32 v27, v27, v59
    v_add_f32 v28, v28, v60
    v_add_f32 v29, v29, v61
    v_add_f32 v30, v30, v62
    v_add_f32 v31, v31, v63
    s_waitcnt lgkmcnt(0)
    v_add_f32 v16, v16, v104
    v_add_f32 v17, v17, v105
    v_add_f32 v18, v18, v106
    v_add_f32 v19, v19, v107
    v_add_f32 v20, v20, v108
    v_add_f32 v21, v21, v109
    v_add_f32 v22, v22, v110
    v_add_f32 v23, v23, v111
    v_add_f32 v24, v24, v112
    v_add_f32 v25, v25, v113
    v_add_f32 v26, v26, v114
    v_add_f32 v27, v27, v115
    v_add_f32 v28, v28, v116
    v_add_f32 v29, v29, v117
    v_add_f32 v30, v30, v118
    v_add_f32 v31, v31, v119
    v_mov_b32 v32, v28
    v_mov_b32 v33, v32
    s_nop 1
    v_permlane32_swap_b32 v32, v33
    v_rcp_f32 v33, v33
    s_nop 0
    v_mul_f32 v16, v16, v33
    v_mul_f32 v17, v17, v33
    v_mul_f32 v18, v18, v33
    v_mul_f32 v19, v19, v33
    v_mul_f32 v20, v20, v33
    v_mul_f32 v21, v21, v33
    v_mul_f32 v22, v22, v33
    v_mul_f32 v23, v23, v33
    v_mul_f32 v24, v24, v33
    v_mul_f32 v25, v25, v33
    v_mul_f32 v26, v26, v33
    v_mul_f32 v27, v27, v33
    v_mul_f32 v28, v28, v33
    v_mul_f32 v29, v29, v33
    v_mul_f32 v30, v30, v33
    v_mul_f32 v31, v31, v33
    v_cvt_pk_bf16_f32 v40, v16, v17
    v_cvt_pk_bf16_f32 v41, v18, v19
    v_cvt_pk_bf16_f32 v42, v20, v21
    v_cvt_pk_bf16_f32 v43, v22, v23
    v_cvt_pk_bf16_f32 v44, v24, v25
    v_cvt_pk_bf16_f32 v45, v26, v27
    v_cvt_pk_bf16_f32 v46, v28, v29
    v_cvt_pk_bf16_f32 v47, v30, v31
    s_mov_b64 exec, s[76:77]
    v_mov_b32 v46, 0
    v_mov_b32 v47, 0
    s_mov_b64 exec, -1
    s_cmp_lg_u32 s3, 0
    s_cbranch_scc1 L_hn_74
    buffer_store_dwordx4 v[40:43], v1, s[16:19], s89 offen sc1
    buffer_store_dwordx4 v[44:47], v1, s[16:19], s89 offen offset:1024 sc1
    s_branch L_hd_75
L_hn_74:
    buffer_store_dwordx4 v[40:43], v1, s[16:19], s89 offen
    buffer_store_dwordx4 v[44:47], v1, s[16:19], s89 offen offset:1024
L_hd_75:
    s_waitcnt vmcnt(0)
    s_mov_b64 exec, 1
    v_mov_b32 v4, 159812
    v_mov_b32 v5, 1
    ds_add_rtn_u32 v5, v4, v5
    s_lshl_b32 s80, s70, 3
    s_add_u32 s80, s80, s71
    s_lshl_b32 s80, s80, 7
    s_add_u32 s80, s80, 425984
    s_waitcnt lgkmcnt(0)
    v_readfirstlane_b32 s81, v5
    s_cmp_lg_u32 s81, 3
    s_cbranch_scc1 L_sg_76
    s_mov_b64 exec, 255
    v_mov_b32 v4, s66
    v_mov_b32 v5, s67
    v_mov_b32 v6, s75
    s_cmp_lg_u32 s3, 0
    s_cbranch_scc1 L_hn_77
    buffer_store_dwordx4 v[4:7], v1, s[16:19], s80 offen sc1
    s_branch L_hd_78
L_hn_77:
    buffer_store_dwordx4 v[4:7], v1, s[16:19], s80 offen
L_hd_78:
L_sg_76:
    s_mov_b64 exec, -1
    s_nop 0
    s_cmp_eq_u32 s71, 0
    s_cbranch_scc1 L_attend
    s_lshl_b32 s80, s74, 1
    s_add_u32 s80, s80, s73
    s_lshl_b32 s80, s80, 14
    v_add_u32 v8, s80, v1
    v_bfe_u32 v4, v0, 4, 1
    v_and_b32 v6, 3, v0
    v_lshlrev_b32 v6, 3, v6
    v_lshl_add_u32 v6, v4, 5, v6
    v_bfe_u32 v4, v0, 3, 1
    v_xor_b32 v4, s73, v4
    v_lshl_add_u32 v6, v4, 6, v6
    v_add_u32 v9, v6, v3
    s_mul_i32 s80, s69, 14336
    v_add_u32 v14, s80, v1
    s_mul_i32 s80, s69, 11264
    s_add_u32 s80, s80, 114688
    v_add_u32 v15, s80, v1
    v_mov_b32 v4, 159792
    s_mov_b32 s90, 0
L_ls_79:
    ds_read_b32 v5, v4
    s_add_u32 s90, s90, 1
    s_waitcnt lgkmcnt(0)
    v_readfirstlane_b32 s100, v5
    s_cmp_ge_u32 s100, 4
    s_cbranch_scc1 L_lk_80
    s_cmp_lt_u32 s90, 400000
    s_cbranch_scc1 L_ls_79
L_lk_80:
    s_lshl_b32 s80, s73, 1
    s_add_u32 s80, s80, 0
    s_mul_i32 s81, s80, 14336
    s_mul_i32 s80, s80, 11264
    s_add_u32 s80, s80, 114688
    v_add_u32 v10, s81, v9
    v_add_u32 v12, s80, v9
    v_xor_b32 v11, 64, v10
    v_xor_b32 v13, 64, v12
    ds_read_b64_tr_b16 a[0:1], v12 offset:2048
    ds_read_b64_tr_b16 a[2:3], v12 offset:3072
    ds_read_b64_tr_b16 a[4:5], v13 offset:2048
    ds_read_b64_tr_b16 a[6:7], v13 offset:3072
    ds_read_b64_tr_b16 a[8:9], v12 offset:4096
    ds_read_b64_tr_b16 a[10:11], v12 offset:5120
    ds_read_b64_tr_b16 a[12:13], v13 offset:4096
    ds_read_b64_tr_b16 a[14:15], v13 offset:5120
    ds_read_b64_tr_b16 a[16:17], v12 offset:6144
    ds_read_b64_tr_b16 a[18:19], v12 offset:7168
    ds_read_b64_tr_b16 a[20:21], v13 offset:6144
    ds_read_b64_tr_b16 a[22:23], v13 offset:7168
    ds_read_b64_tr_b16 a[24:25], v12 offset:8192
    ds_read_b64_tr_b16 a[26:27], v12 offset:9216
    ds_read_b64_tr_b16 a[28:29], v13 offset:8192
    ds_read_b64_tr_b16 a[30:31], v13 offset:9216
    ds_read_b64_tr_b16 a[32:33], v10 offset:0
    ds_read_b64_tr_b16 a[34:35], v10 offset:1024
    ds_read_b64_tr_b16 a[36:37], v11 offset:0
    ds_read_b64_tr_b16 a[38:39], v11 offset:1024
    ds_read_b64_tr_b16 a[40:41], v10 offset:2048
    ds_read_b64_tr_b16 a[42:43], v10 offset:3072
    ds_read_b64_tr_b16 a[44:45], v11 offset:2048
    ds_read_b64_tr_b16 a[46:47], v11 offset:3072
    ds_read_b64_tr_b16 a[48:49], v10 offset:4096
    ds_read_b64_tr_b16 a[50:51], v10 offset:5120
    ds_read_b64_tr_b16 a[52:53], v11 offset:4096
    ds_read_b64_tr_b16 a[54:55], v11 offset:5120
    ds_read_b64_tr_b16 a[56:57], v10 offset:6144
    ds_read_b64_tr_b16 a[58:59], v10 offset:7168
    ds_read_b64_tr_b16 a[60:61], v11 offset:6144
    ds_read_b64_tr_b16 a[62:63], v11 offset:7168
    s_lshl_b32 s80, s73, 1
    s_add_u32 s80, s80, 1
    s_mul_i32 s81, s80, 14336
    s_mul_i32 s80, s80, 11264
    s_add_u32 s80, s80, 114688
    v_add_u32 v10, s81, v9
    v_add_u32 v12, s80, v9
    v_xor_b32 v11, 64, v10
    v_xor_b32 v13, 64, v12
    ds_read_b64_tr_b16 a[64:65], v12 offset:2048
    ds_read_b64_tr_b16 a[66:67], v12 offset:3072
    ds_read_b64_tr_b16 a[68:69], v13 offset:2048
    ds_read_b64_tr_b16 a[70:71], v13 offset:3072
    ds_read_b64_tr_b16 a[72:73], v12 offset:4096
    ds_read_b64_tr_b16 a[74:75], v12 offset:5120
    ds_read_b64_tr_b16 a[76:77], v13 offset:4096
    ds_read_b64_tr_b16 a[78:79], v13 offset:5120
    ds_read_b64_tr_b16 a[80:81], v12 offset:6144
    ds_read_b64_tr_b16 a[82:83], v12 offset:7168
    ds_read_b64_tr_b16 a[84:85], v13 offset:6144
    ds_read_b64_tr_b16 a[86:87], v13 offset:7168
    ds_read_b64_tr_b16 a[88:89], v12 offset:8192
    ds_read_b64_tr_b16 a[90:91], v12 offset:9216
    ds_read_b64_tr_b16 a[92:93], v13 offset:8192
    ds_read_b64_tr_b16 a[94:95], v13 offset:9216
    ds_read_b64_tr_b16 a[96:97], v10 offset:0
    ds_read_b64_tr_b16 a[98:99], v10 offset:1024
    ds_read_b64_tr_b16 a[100:101], v11 offset:0
    ds_read_b64_tr_b16 a[102:103], v11 offset:1024
    ds_read_b64_tr_b16 a[104:105], v10 offset:2048
    ds_read_b64_tr_b16 a[106:107], v10 offset:3072
    ds_read_b64_tr_b16 a[108:109], v11 offset:2048
    ds_read_b64_tr_b16 a[110:111], v11 offset:3072
    ds_read_b64_tr_b16 a[112:113], v10 offset:4096
    ds_read_b64_tr_b16 a[114:115], v10 offset:5120
    ds_read_b64_tr_b16 a[116:117], v11 offset:4096
    ds_read_b64_tr_b16 a[118:119], v11 offset:5120
    ds_read_b64_tr_b16 a[120:121], v10 offset:6144
    ds_read_b64_tr_b16 a[122:123], v10 offset:7168
    ds_read_b64_tr_b16 a[124:125], v11 offset:6144
    ds_read_b64_tr_b16 a[126:127], v11 offset:7168
    s_lshl_b32 s80, s70, 10
    s_add_u32 s80, s80, 425984
    v_lshlrev_b32 v5, 7, v0
    v_add_u32 v5, s80, v5
    s_lshl_b32 s80, s73, 2
    s_lshl_b32 s80, 15, s80
    s_not_b32 s78, s80
    s_mov_b32 s79, -1
    s_mov_b64 vcc, s[78:79]
    v_mov_b32 v7, 2147418112
    v_cndmask_b32 v6, v5, v7, vcc
    buffer_load_dwordx2 v[4:5], v6, s[16:19], 0 offen sc1
    s_mov_b32 s91, 12582912
    s_mov_b32 s92, 12587008
    s_mov_b32 s96, 12591104
    s_mov_b32 s97, 12595200
    s_waitcnt vmcnt(0)
    s_mov_b32 s90, 20000
L_ps_81:
    v_cmp_eq_u64 vcc, s[66:67], v[4:5]
    s_or_b64 vcc, vcc, s[78:79]
    s_cmp_eq_u64 vcc, -1
    s_cbranch_scc1 L_pk_82
    s_sub_u32 s90, s90, 1
    s_cbranch_scc1 L_pk_82
    buffer_load_dwordx2 v[4:5], v6, s[16:19], 0 offen sc1
    s_waitcnt vmcnt(0)
    s_branch L_ps_81
L_pk_82:
    s_setprio 0
    buffer_load_dwordx4 v[48:51], v8, s[16:19], s91 offen offset:0 sc1
    buffer_load_dwordx4 v[52:55], v8, s[16:19], s91 offen offset:1024 sc1
    buffer_load_dwordx4 v[56:59], v8, s[16:19], s91 offen offset:2048 sc1
    buffer_load_dwordx4 v[60:63], v8, s[16:19], s91 offen offset:3072 sc1
    buffer_load_dwordx4 v[64:67], v8, s[16:19], s92 offen offset:0 sc1
    buffer_load_dwordx4 v[68:71], v8, s[16:19], s92 offen offset:1024 sc1
    s_waitcnt lgkmcnt(0)
    s_waitcnt vmcnt(5)
    v_mfma_f32_32x32x16_bf16 v[16:31], a[0:3], v[48:51], 0
    buffer_load_dwordx4 v[72:75], v8, s[16:19], s92 offen offset:2048 sc1
    v_mfma_f32_32x32x16_bf16 v[32:47], a[4:7], v[48:51], 0
    s_waitcnt vmcnt(5)
    v_mfma_f32_32x32x16_bf16 v[16:31], a[8:11], v[52:55], v[16:31]
    buffer_load_dwordx4 v[76:79], v8, s[16:19], s92 offen offset:3072 sc1
    v_mfma_f32_32x32x16_bf16 v[32:47], a[12:15], v[52:55], v[32:47]
    s_waitcnt vmcnt(5)
    v_mfma_f32_32x32x16_bf16 v[16:31], a[16:19], v[56:59], v[16:31]
    buffer_load_dwordx4 v[80:83], v8, s[16:19], s96 offen offset:0 sc1
    v_mfma_f32_32x32x16_bf16 v[32:47], a[20:23], v[56:59], v[32:47]
    s_waitcnt vmcnt(5)
    v_mfma_f32_32x32x16_bf16 v[16:31], a[24:27], v[60:63], v[16:31]
    buffer_load_dwordx4 v[84:87], v8, s[16:19], s96 offen offset:1024 sc1
    v_mfma_f32_32x32x16_bf16 v[32:47], a[28:31], v[60:63], v[32:47]
    s_waitcnt vmcnt(5)
    v_mfma_f32_32x32x16_bf16 v[16:31], a[32:35], v[64:67], v[16:31]
    buffer_load_dwordx4 v[88:91], v8, s[16:19], s96 offen offset:2048 sc1
    v_mfma_f32_32x32x16_bf16 v[32:47], a[36:39], v[64:67], v[32:47]
    s_waitcnt vmcnt(5)
    v_mfma_f32_32x32x16_bf16 v[16:31], a[40:43], v[68:71], v[16:31]
    buffer_load_dwordx4 v[92:95], v8, s[16:19], s96 offen offset:3072 sc1
    v_mfma_f32_32x32x16_bf16 v[32:47], a[44:47], v[68:71], v[32:47]
    s_waitcnt vmcnt(5)
    v_mfma_f32_32x32x16_bf16 v[16:31], a[48:51], v[72:75], v[16:31]
    buffer_load_dwordx4 v[96:99], v8, s[16:19], s97 offen offset:0 sc1
    v_mfma_f32_32x32x16_bf16 v[32:47], a[52:55], v[72:75], v[32:47]
    s_waitcnt vmcnt(5)
    v_mfma_f32_32x32x16_bf16 v[16:31], a[56:59], v[76:79], v[16:31]
    buffer_load_dwordx4 v[100:103], v8, s[16:19], s97 offen offset:1024 sc1
    v_mfma_f32_32x32x16_bf16 v[32:47], a[60:63], v[76:79], v[32:47]
    s_waitcnt vmcnt(5)
    v_mfma_f32_32x32x16_bf16 v[16:31], a[64:67], v[80:83], v[16:31]
    buffer_load_dwordx4 v[104:107], v8, s[16:19], s97 offen offset:2048 sc1
    v_mfma_f32_32x32x16_bf16 v[32:47], a[68:71], v[80:83], v[32:47]
    s_waitcnt vmcnt(5)
    v_mfma_f32_32x32x16_bf16 v[16:31], a[72:75], v[84:87], v[16:31]
    buffer_load_dwordx4 v[108:111], v8, s[16:19], s97 offen offset:3072 sc1
    v_mfma_f32_32x32x16_bf16 v[32:47], a[76:79], v[84:87], v[32:47]
    s_waitcnt vmcnt(5)
    v_mfma_f32_32x32x16_bf16 v[16:31], a[80:83], v[88:91], v[16:31]
    v_mfma_f32_32x32x16_bf16 v[32:47], a[84:87], v[88:91], v[32:47]
    s_waitcnt vmcnt(4)
    v_mfma_f32_32x32x16_bf16 v[16:31], a[88:91], v[92:95], v[16:31]
    v_mfma_f32_32x32x16_bf16 v[32:47], a[92:95], v[92:95], v[32:47]
    s_waitcnt vmcnt(3)
    v_mfma_f32_32x32x16_bf16 v[16:31], a[96:99], v[96:99], v[16:31]
    v_mfma_f32_32x32x16_bf16 v[32:47], a[100:103], v[96:99], v[32:47]
    s_waitcnt vmcnt(2)
    v_mfma_f32_32x32x16_bf16 v[16:31], a[104:107], v[100:103], v[16:31]
    v_mfma_f32_32x32x16_bf16 v[32:47], a[108:111], v[100:103], v[32:47]
    s_waitcnt vmcnt(1)
    v_mfma_f32_32x32x16_bf16 v[16:31], a[112:115], v[104:107], v[16:31]
    v_mfma_f32_32x32x16_bf16 v[32:47], a[116:119], v[104:107], v[32:47]
    s_waitcnt vmcnt(0)
    v_mfma_f32_32x32x16_bf16 v[16:31], a[120:123], v[108:111], v[16:31]
    v_mfma_f32_32x32x16_bf16 v[32:47], a[124:127], v[108:111], v[32:47]
    s_nop 10
    ds_write_b128 v14, v[16:19] offset:8192
    ds_write_b128 v14, v[20:23] offset:9216
    ds_write_b128 v14, v[24:27] offset:10240
    ds_write_b128 v14, v[28:31] offset:11264
    ds_write_b128 v14, v[32:35] offset:12288
    ds_write_b128 v14, v[36:39] offset:13312
    ds_write_b128 v15, v[40:43] offset:0
    ds_write_b128 v15, v[44:47] offset:1024
    s_lshl_b32 s80, s72, 2
    s_add_u32 s80, s80, 159864
    s_mov_b64 exec, 1
    v_mov_b32 v4, s80
    v_mov_b32 v5, 1
    ds_add_u32 v4, v5
    s_mov_b64 exec, -1
L_attend:
    s_endpgm
L_slow:
    v_mov_b32 v108, 0xff800000
    v_mov_b32 v109, 0xff800000
    v_mov_b32 v110, 0xff800000
    v_mov_b32 v111, 0xff800000
    s_mov_b32 s84, 0
L_sloop:
    buffer_load_dwordx4 v[112:115], v104, s[16:19], s84 offen sc1
    buffer_load_dwordx4 v[116:119], v104, s[16:19], s84 offen offset:1024 sc1
    s_add_u32 s84, s84, 4096
    s_waitcnt vmcnt(0)
    v_mfma_f32_32x32x16_bf16 v[32:47], v[112:115], a[48:51], 0
    v_mfma_f32_32x32x16_bf16 v[32:47], v[116:119], a[52:55], v[32:47]
    s_nop 11
    v_max3_f32 v108, v108, v32, v33
    v_max3_f32 v108, v108, v34, v35
    v_max3_f32 v108, v108, v36, v37
    v_max3_f32 v108, v108, v38, v39
    v_max3_f32 v108, v108, v40, v41
    v_max3_f32 v108, v108, v42, v43
    v_max3_f32 v108, v108, v44, v45
    v_max3_f32 v108, v108, v46, v47
    v_mfma_f32_32x32x16_bf16 v[32:47], v[112:115], a[56:59], 0
    v_mfma_f32_32x32x16_bf16 v[32:47], v[116:119], a[60:63], v[32:47]
    s_nop 11
    v_max3_f32 v109, v109, v32, v33
    v_max3_f32 v109, v109, v34, v35
    v_max3_f32 v109, v109, v36, v37
    v_max3_f32 v109, v109, v38, v39
    v_max3_f32 v109, v109, v40, v41
    v_max3_f32 v109, v109, v42, v43
    v_max3_f32 v109, v109, v44, v45
    v_max3_f32 v109, v109, v46, v47
    v_mfma_f32_32x32x16_bf16 v[32:47], v[112:115], a[64:67], 0
    v_mfma_f32_32x32x16_bf16 v[32:47], v[116:119], a[68:71], v[32:47]
    s_nop 11
    v_max3_f32 v110, v110, v32, v33
    v_max3_f32 v110, v110, v34, v35
    v_max3_f32 v110, v110, v36, v37
    v_max3_f32 v110, v110, v38, v39
    v_max3_f32 v110, v110, v40, v41
    v_max3_f32 v110, v110, v42, v43
    v_max3_f32 v110, v110, v44, v45
    v_max3_f32 v110, v110, v46, v47
    v_mfma_f32_32x32x16_bf16 v[32:47], v[112:115], a[72:75], 0
    v_mfma_f32_32x32x16_bf16 v[32:47], v[116:119], a[76:79], v[32:47]
    s_nop 11
    v_max3_f32 v111, v111, v32, v33
    v_max3_f32 v111, v111, v34, v35
    v_max3_f32 v111, v111, v36, v37
    v_max3_f32 v111, v111, v38, v39
    v_max3_f32 v111, v111, v40, v41
    v_max3_f32 v111, v111, v42, v43
    v_max3_f32 v111, v111, v44, v45
    v_max3_f32 v111, v111, v46, v47
    s_cmp_lt_u32 s84, 0x10000
    s_cbranch_scc1 L_sloop
    v_and_b32 v112, 31, v0
    v_lshlrev_b32 v112, 2, v112
    v_add_u32 v112, 160000, v112
    v_mov_b32 v113, v108
    s_nop 1
    v_permlane32_swap_b32 v108, v113
    v_max_f32 v108, v108, v113
    s_xor_b32 s80, s69, 0
    s_lshl_b32 s80, s80, 7
    v_add_u32 v116, s80, v112
    v_mov_b32 v113, v109
    s_nop 1
    v_permlane32_swap_b32 v109, v113
    v_max_f32 v109, v109, v113
    s_xor_b32 s80, s69, 1
    s_lshl_b32 s80, s80, 7
    v_add_u32 v117, s80, v112
    v_mov_b32 v113, v110
    s_nop 1
    v_permlane32_swap_b32 v110, v113
    v_max_f32 v110, v110, v113
    s_xor_b32 s80, s69, 2
    s_lshl_b32 s80, s80, 7
    v_add_u32 v118, s80, v112
    v_mov_b32 v113, v111
    s_nop 1
    v_permlane32_swap_b32 v111, v113
    v_max_f32 v111, v111, v113
    s_xor_b32 s80, s69, 3
    s_lshl_b32 s80, s80, 7
    v_add_u32 v119, s80, v112
    ds_write_b32 v116, v108
    s_mov_b64 exec, 1
    v_mov_b32 v4, 159764
    v_mov_b32 v5, 1
    ds_add_u32 v4, v5
    s_mov_b64 exec, -1
    v_mov_b32 v4, 159764
    s_mov_b32 s90, 0
L_ls_83:
    ds_read_b32 v5, v4
    s_add_u32 s90, s90, 1
    s_waitcnt lgkmcnt(0)
    v_readfirstlane_b32 s100, v5
    s_cmp_ge_u32 s100, 4
    s_cbranch_scc1 L_lk_84
    s_cmp_lt_u32 s90, 400000
    s_cbranch_scc1 L_ls_83
L_lk_84:
    ds_max_f32 v117, v109
    ds_max_f32 v118, v110
    ds_max_f32 v119, v111
    s_mov_b64 exec, 1
    v_mov_b32 v4, 159764
    v_mov_b32 v5, 1
    ds_add_u32 v4, v5
    s_mov_b64 exec, -1
    v_mov_b32 v4, 159764
    s_mov_b32 s90, 0
L_ls_85:
    ds_read_b32 v5, v4
    s_add_u32 s90, s90, 1
    s_waitcnt lgkmcnt(0)
    v_readfirstlane_b32 s100, v5
    s_cmp_ge_u32 s100, 8
    s_cbranch_scc1 L_lk_86
    s_cmp_lt_u32 s90, 400000
    s_cbranch_scc1 L_ls_85
L_lk_86:
    ds_read_b32 v120, v116
    s_waitcnt lgkmcnt(0)
    v_sub_f32 v120, 0, v120
    v_cvt_pk_bf16_f32 v121, v120, v120
    v_and_b32 v121, 0xffff0000, v121
    v_sub_f32 v122, v120, v121
    v_cvt_pk_bf16_f32 v123, v120, v122
    v_and_b32 v121, 0xffff0000, v123
    v_sub_f32 v122, v122, v121
    v_cvt_pk_bf16_f32 v122, v122, 0
    s_mov_b64 exec, s[76:77]
    v_accvgpr_write_b32 a54, v123
    v_accvgpr_write_b32 a55, v122
    s_mov_b64 exec, -1
    ds_read_b32 v120, v117
    s_waitcnt lgkmcnt(0)
    v_sub_f32 v120, 0, v120
    v_cvt_pk_bf16_f32 v121, v120, v120
    v_and_b32 v121, 0xffff0000, v121
    v_sub_f32 v122, v120, v121
    v_cvt_pk_bf16_f32 v123, v120, v122
    v_and_b32 v121, 0xffff0000, v123
    v_sub_f32 v122, v122, v121
    v_cvt_pk_bf16_f32 v122, v122, 0
    s_mov_b64 exec, s[76:77]
    v_accvgpr_write_b32 a62, v123
    v_accvgpr_write_b32 a63, v122
    s_mov_b64 exec, -1
    ds_read_b32 v120, v118
    s_waitcnt lgkmcnt(0)
    v_sub_f32 v120, 0, v120
    v_cvt_pk_bf16_f32 v121, v120, v120
    v_and_b32 v121, 0xffff0000, v121
    v_sub_f32 v122, v120, v121
    v_cvt_pk_bf16_f32 v123, v120, v122
    v_and_b32 v121, 0xffff0000, v123
    v_sub_f32 v122, v122, v121
    v_cvt_pk_bf16_f32 v122, v122, 0
    s_mov_b64 exec, s[76:77]
    v_accvgpr_write_b32 a70, v123
    v_accvgpr_write_b32 a71, v122
    s_mov_b64 exec, -1
    ds_read_b32 v120, v119
    s_waitcnt lgkmcnt(0)
    v_sub_f32 v120, 0, v120
    v_cvt_pk_bf16_f32 v121, v120, v120
    v_and_b32 v121, 0xffff0000, v121
    v_sub_f32 v122, v120, v121
    v_cvt_pk_bf16_f32 v123, v120, v122
    v_and_b32 v121, 0xffff0000, v123
    v_sub_f32 v122, v122, v121
    v_cvt_pk_bf16_f32 v122, v122, 0
    s_mov_b64 exec, s[76:77]
    v_accvgpr_write_b32 a78, v123
    v_accvgpr_write_b32 a79, v122
    s_mov_b64 exec, -1
    s_nop 1
    s_branch L_fast
L_end:
    s_endpgm
L_code_end:
.section .rodata,"a"
.p2align 6
.amdhsa_kernel recurrent_scan__grouped_kv_mqa__mixer_s_mlp__prompt_kernel
  .amdhsa_next_free_vgpr 256
  .amdhsa_next_free_sgpr 102
  .amdhsa_accum_offset 128
  .amdhsa_group_segment_fixed_size 0
  .amdhsa_kernarg_size 104
  .amdhsa_user_sgpr_count 2
  .amdhsa_user_sgpr_kernarg_segment_ptr 1
  .amdhsa_system_sgpr_workgroup_id_x 1
.end_amdhsa_kernel
```
